```python
import torch

def _softmax(x, axis=-1):
    return torch.softmax(x, dim=axis)
def _gelu(x):
    return torch.nn.functional.gelu(x, approximate="tanh")
def _silu(x):
    return torch.nn.functional.silu(x)
def _sigmoid(x):
    return torch.sigmoid(x)
def _layernorm(x, axis=-1, eps=1e-5):
    m = x.mean(dim=axis, keepdim=True)
    v = x.var(dim=axis, keepdim=True, unbiased=False)
    return (x - m) / torch.sqrt(v + eps)
def _scatter_add(tgt, idx, src, axis=0):
    return tgt.clone().index_add_(axis, idx, src)
def _segment_sum(src, seg, n):
    out = torch.zeros((n,) + src.shape[1:], dtype=src.dtype)
    return out.index_add_(0, seg, src)
def _pad(x, pw):
    flat = tuple(v for pair in reversed(pw) for v in pair)
    return torch.nn.functional.pad(x, flat)

kernel_name = 'gated_mix__linear_kernel_hedgehog__glu_gated_swiglu__prompt'

def setup_inputs():

    _w = (lambda a: (lambda t: t.to(torch.bfloat16) if t.is_floating_point() else t)(torch.as_tensor(a)))
    def _A_setup():
        B, S, D, H = 1, 2048, 448, 16
        Dh = D // H
        return {
            "x": _w((lambda *s: torch.randn(*s, dtype=torch.bfloat16) * 0.05)(B, S, D)),
            "wqkv": _w((lambda *s: torch.randn(*s, dtype=torch.bfloat16) * 0.8)(D, 3 * D)),
            "w_phi": _w((lambda *s: torch.randn(*s, dtype=torch.bfloat16) * 0.8)(H, Dh, Dh) * (Dh ** -0.5)),
            "wo": _w((lambda *s: torch.randn(*s, dtype=torch.bfloat16) * 0.05)(D, D)),
        }
    _A_in = _A_setup()

    def _B_setup():
        B, S, D, F = 1, 2048, 448, 1792
        return {
            "x": _w((lambda *s: torch.randn(*s, dtype=torch.bfloat16) * 0.05)(B, S, D)),
            "w1": _w((lambda *s: torch.randn(*s, dtype=torch.bfloat16) * 1.6)(D, F) * (2.0 / D) ** 0.5),
            "w3": _w((lambda *s: torch.randn(*s, dtype=torch.bfloat16) * 1.6)(D, F) * (2.0 / D) ** 0.5),
            "w2": _w((lambda *s: torch.randn(*s, dtype=torch.bfloat16) * 1.6)(F, D) * (2.0 / F) ** 0.5),
        }
    _B_in = _B_setup()

    return {
        "A_x": _A_in["x"],
        "A_wqkv": _A_in["wqkv"],
        "A_w_phi": _A_in["w_phi"],
        "A_wo": _A_in["wo"],
        "B_x": _B_in["x"],
        "B_w1": _B_in["w1"],
        "B_w3": _B_in["w3"],
        "B_w2": _B_in["w2"],
        "gate_w": _w((lambda *s: torch.randn(*s, dtype=torch.bfloat16) * 0.05)(448) * 16.0),
    }

def reference(A_x, A_wqkv, A_w_phi, A_wo, B_x, B_w1, B_w3, B_w2, gate_w):
    def _A_ref(x, wqkv, w_phi, wo):
        B, S, D = x.shape
        H = 16; Dh = D // H
        qkv = (lambda x, *d: x.permute(*d))((x @ wqkv).reshape(B, S, 3, H, Dh), 2, 0, 3, 1, 4)
        q, k, v = qkv[0], qkv[1], qkv[2]
        pq = torch.einsum("bhsd,hdf->bhsf", q, w_phi)
        pk = torch.einsum("bhsd,hdf->bhsf", k, w_phi)
        phi_q = torch.concatenate([_softmax(pq, axis=-1), _softmax(-pq, axis=-1)], axis=-1)
        phi_k = torch.concatenate([_softmax(pk, axis=-1), _softmax(-pk, axis=-1)], axis=-1)
        kv = torch.einsum("bhsf,bhsd->bhfd", phi_k, v)
        z  = torch.einsum("bhsf->bhf", phi_k)
        num = torch.einsum("bhqf,bhfd->bhqd", phi_q, kv)
        den = torch.einsum("bhqf,bhf->bhq", phi_q, z)[..., None] + 1e-6
        o = num / den
        return (lambda x, *d: x.permute(*d))(o, 0, 2, 1, 3).reshape(B, S, D) @ wo

    def _B_ref(x, w1, w3, w2):
        gate = torch.einsum("bsd,df->bsf", x, w1)
        up = torch.einsum("bsd,df->bsf", x, w3)
        h = _silu(gate) * up
        out = torch.einsum("bsf,fd->bsd", h, w2)
        return out

    x = A_x
    g = _sigmoid((x * gate_w).sum(-1, keepdims=True))
    a = _A_ref(x, A_wqkv, A_w_phi, A_wo)
    b = _B_ref(x, B_w1, B_w3, B_w2)
    return g * a + (1 - g) * b
```

```asm
; @launch grid=(256,1,1) block=(512,1,1) lds=163840
.amdgcn_target "amdgcn-amd-amdhsa--gfx950"
.text
.globl gated_mix__linear_kernel_hedgehog__glu_gated_swiglu__prompt_kernel
.p2align 8
.type gated_mix__linear_kernel_hedgehog__glu_gated_swiglu__prompt_kernel,@function
gated_mix__linear_kernel_hedgehog__glu_gated_swiglu__prompt_kernel:
    s_cmp_ge_u32 s2, 256
    s_cbranch_scc1 L_end
    s_load_dwordx16 s[4:19], s[0:1], 0
    s_load_dwordx8 s[20:27], s[0:1], 64
    s_getpc_b64 s[48:49]
    s_add_u32 s2, s2, 160
    s_and_b32 s2, s2, 255
    s_cmp_ge_u32 s2, 224
    s_cbranch_scc1 L_q
    s_cmp_ge_u32 s2, 160
    s_cbranch_scc1 L_kv
    v_lshrrev_b32 v1, 6, v0
    v_and_b32 v0, 63, v0
    v_readfirstlane_b32 s60, v1
    s_and_b32 s61, s2, 7
    s_lshr_b32 s62, s2, 3
    s_mov_b32 s70, 0x3fb8aa3b
    s_and_b32 s48, s48, 0xffffff00
    s_mov_b32 s50, L_code_end-gated_mix__linear_kernel_hedgehog__glu_gated_swiglu__prompt_kernel
    s_mov_b32 s51, 0x20000
    s_and_b32 s63, s62, 7
    s_lshl_b32 s63, s63, 3
    s_add_u32 s63, s63, s60
    s_mul_i32 s63, s63, 768
    v_min_u32 v2, 5, v0
    v_lshlrev_b32 v2, 7, v2
    buffer_load_dword v16, v2, s[48:51], s63 offen
    v_mov_b32 v18, 1
    v_cmp_eq_u32 vcc, 0, v0
    v_mov_b32 v17, 0x4000000
    v_lshlrev_b32 v1, 4, v0
    s_lshl_b32 s69, s60, 10
    v_cndmask_b32 v17, v17, v0, vcc
    s_and_b32 s63, s60, 1
    s_lshl_b32 s63, s63, 2
    v_lshrrev_b32 v28, 4, v0
    v_add_u32 v28, s63, v28
    v_and_b32 v29, 7, v0
    v_xor_b32 v28, v28, v29
    v_lshlrev_b32 v28, 4, v28
    v_lshrrev_b32 v29, 3, v0
    v_mul_u32_u24 v29, 896, v29
    v_add_u32 v4, v28, v29
    s_lshr_b32 s75, s61, 2
    s_xor_b32 s75, s75, s61
    s_and_b32 s75, s75, 1
    s_mul_i32 s75, s75, 4
    s_setprio 1
    s_mul_i32 s63, s61, 20
    s_add_u32 s63, s63, s62
    s_cmp_ge_u32 s63, 154
    s_cbranch_scc1 L_janitor
    s_mul_i32 s73, s63, 171
    s_lshr_b32 s73, s73, 10
    s_mul_i32 s72, s73, 6
    s_sub_u32 s72, s63, s72
    s_sub_u32 s64, s63, 84
    s_max_i32 s64, s64, 0
    s_mul_i32 s65, s64, 103
    s_lshr_b32 s65, s65, 9
    s_mul_i32 s66, s65, 5
    s_sub_u32 s66, s64, s66
    s_add_u32 s66, s66, 6
    s_cmp_ge_u32 s63, 84
    s_cselect_b32 s73, s65, s73
    s_cselect_b32 s72, s66, s72
    s_add_u32 s78, s72, s73
    s_and_b32 s78, s78, 1
    s_mul_i32 s64, s78, 4
    s_xor_b32 s64, s64, s60
    s_lshl_b32 s69, s64, 10
    s_mul_i32 s67, s64, 14336
    s_lshl_b32 s63, s73, 8
    s_add_u32 s67, s67, s63
    s_mul_i32 s68, s72, 172032
    s_mul_i32 s63, s64, 7168
    s_add_u32 s68, s68, s63
    v_lshrrev_b32 v28, 4, v0
    v_lshlrev_b32 v29, 6, v28
    v_and_b32 v30, 0xf0, v1
    v_xor_b32 v29, v29, v30
    v_mul_u32_u24 v28, 3584, v28
    s_and_b32 s63, s60, 2
    s_lshl_b32 s63, s63, 4
    v_add_u32 v2, v28, v29
    v_xor_b32 v2, s63, v2
    s_mov_b32 s30, 0x1c0000
    s_mov_b32 s31, 0x20000
    s_mov_b32 s34, 0x188000
    s_mov_b32 s35, 0x20000
    s_mov_b32 s38, 0x188000
    s_mov_b32 s39, 0x20000
    s_mov_b32 s42, 0xa00000
    s_mov_b32 s43, 0x20000
    s_mov_b32 s58, 0x100
    s_mov_b32 s59, 0x20000
    s_waitcnt lgkmcnt(0)
    s_mov_b64 s[28:29], s[4:5]
    s_mov_b64 s[32:33], s[14:15]
    s_mov_b64 s[36:37], s[16:17]
    s_mov_b64 s[40:41], s[26:27]
    s_mov_b64 s[56:57], s[24:25]
    s_cmp_lg_u32 s72, 10
    s_cbranch_scc1 L_no_warm
    s_mov_b32 s44, s6
    s_mov_b32 s45, s7
    s_mov_b32 s46, 0x126000
    s_mov_b32 s47, 0x20000
    s_lshl_b32 s63, s73, 3
    s_add_u32 s63, s63, s60
    v_lshlrev_b32 v33, 7, v0
    v_lshlrev_b32 v34, 7, v0
    v_mul_u32_u24 v35, 896, v0
    v_cmp_gt_u32 vcc, 16, v0
    v_mov_b32 v28, 0x4000000
    s_nop 0
    v_cndmask_b32 v33, v28, v33, vcc
    v_cmp_gt_u32 vcc, 12, v0
    v_mov_b32 v28, 0x4000000
    s_nop 0
    v_cndmask_b32 v34, v28, v34, vcc
    v_cmp_gt_u32 vcc, 19, v0
    v_mov_b32 v28, 0x4000000
    s_nop 0
    v_cndmask_b32 v35, v28, v35, vcc
    s_mul_i32 s64, s63, 2048
    s_add_u32 s64, s64, 688128
    s_mul_i32 s65, s63, 1536
    s_add_u32 s65, s65, 516096
    s_mul_i32 s66, s63, 17024
    s_add_u32 s66, s66, 384
    buffer_load_dword v36, v33, s[32:35], s64 offen
    buffer_load_dword v37, v33, s[36:39], s64 offen
    buffer_load_dword v38, v34, s[44:47], s65 offen
    buffer_load_dword v39, v35, s[28:31], s66 offen
L_no_warm:
    s_mov_b32 s24, s75
    s_mul_i32 s25, s24, 229376
    s_add_u32 s25, s25, s67
    s_lshl_b32 s26, s24, 7
    s_add_u32 s26, s26, s68
    s_add_u32 m0, s69, 32768
    s_add_u32 s74, s26, 0
    buffer_load_dwordx4 v4, s[28:31], s74 offen lds
    s_add_u32 m0, s69, 0
    s_add_u32 s74, s25, 0
    buffer_load_dwordx4 v2, s[32:35], s74 offen lds
    s_add_u32 m0, s69, 16384
    s_add_u32 s74, s25, 0
    buffer_load_dwordx4 v2, s[36:39], s74 offen lds
    s_add_u32 m0, s69, 40960
    s_add_u32 s74, s26, 57344
    buffer_load_dwordx4 v4, s[28:31], s74 offen lds
    s_add_u32 m0, s69, 8192
    s_add_u32 s74, s25, 114688
    buffer_load_dwordx4 v2, s[32:35], s74 offen lds
    s_add_u32 m0, s69, 24576
    s_add_u32 s74, s25, 114688
    buffer_load_dwordx4 v2, s[36:39], s74 offen lds
    s_xor_b32 s63, s78, 0
    s_mul_i32 s6, s63, 57344
    s_mul_i32 s7, s63, 114688
    s_lshl_b32 s8, s63, 13
    s_add_u32 s8, s8, s69
    s_xor_b32 s63, s78, 1
    s_mul_i32 s9, s63, 57344
    s_mul_i32 s20, s63, 114688
    s_lshl_b32 s21, s63, 13
    s_add_u32 s21, s21, s69
    v_bfe_u32 v28, v0, 2, 2
    v_bfe_u32 v29, v0, 4, 1
    v_lshlrev_b32 v30, 6, v28
    v_lshl_add_u32 v30, v29, 5, v30
    v_and_b32 v31, 1, v0
    v_lshlrev_b32 v31, 4, v31
    v_bfe_u32 v29, v0, 1, 1
    v_lshl_add_u32 v31, v29, 3, v31
    s_lshl_b32 s63, s60, 5
    v_add_u32 v31, s63, v31
    v_xor_b32 v30, v30, v31
    v_lshrrev_b32 v31, 4, v0
    v_lshl_add_u32 v29, v31, 3, v28
    v_lshl_add_u32 v5, v29, 8, v30
    v_bfe_u32 v28, v0, 1, 3
    v_xor_b32 v28, v28, v31
    v_lshlrev_b32 v28, 4, v28
    v_and_b32 v29, 15, v0
    v_lshl_add_u32 v6, v29, 7, v28
    v_xor_b32 v7, 64, v6
    s_barrier
    s_add_u32 s24, s24, 1
    s_cmp_eq_u32 s24, 7
    s_cselect_b32 s24, 0, s24
    s_mul_i32 s25, s24, 229376
    s_add_u32 s25, s25, s67
    s_lshl_b32 s26, s24, 7
    s_add_u32 s26, s26, s68
    s_add_u32 m0, s69, 131072
    s_add_u32 s74, s26, 0
    buffer_load_dwordx4 v4, s[28:31], s74 offen lds
    s_add_u32 m0, s69, 98304
    s_add_u32 s74, s25, 0
    buffer_load_dwordx4 v2, s[32:35], s74 offen lds
    s_add_u32 m0, s69, 114688
    s_add_u32 s74, s25, 0
    buffer_load_dwordx4 v2, s[36:39], s74 offen lds
    s_add_u32 m0, s69, 139264
    s_add_u32 s74, s26, 57344
    buffer_load_dwordx4 v4, s[28:31], s74 offen lds
    s_add_u32 m0, s69, 106496
    s_add_u32 s74, s25, 114688
    buffer_load_dwordx4 v2, s[32:35], s74 offen lds
    s_add_u32 m0, s69, 122880
    s_add_u32 s74, s25, 114688
    buffer_load_dwordx4 v2, s[36:39], s74 offen lds
    s_waitcnt vmcnt(6)
    s_barrier
    ds_read_b64_tr_b16 v[144:145], v5 offset:0
    ds_read_b64_tr_b16 v[146:147], v5 offset:1024
    ds_read_b128 v[32:35], v6 offset:32768
    ds_read_b64_tr_b16 v[148:149], v5 offset:16384
    ds_read_b64_tr_b16 v[150:151], v5 offset:17408
    ds_read_b128 v[36:39], v6 offset:36864
    ds_read_b128 v[40:43], v6 offset:40960
    ds_read_b128 v[44:47], v6 offset:45056
    s_waitcnt lgkmcnt(5)
    v_mfma_f32_16x16x32_bf16 v[64:67], v[144:147], v[32:35], 0
    ds_read_b128 v[48:51], v6 offset:34816
    s_mul_i32 s71, s72, 672
    s_lshl_b32 s63, s73, 3
    s_add_u32 s71, s71, s63
    s_waitcnt lgkmcnt(4)
    v_mfma_f32_16x16x32_bf16 v[72:75], v[148:151], v[32:35], 0
    ds_read_b128 v[52:55], v6 offset:38912
    s_add_u32 s71, s71, s60
    s_mul_i32 s3, s72, 84
    s_add_u32 s3, s3, s73
    s_waitcnt lgkmcnt(4)
    v_mfma_f32_16x16x32_bf16 v[80:83], v[144:147], v[36:39], 0
    ds_read_b128 v[56:59], v6 offset:43008
    v_mfma_f32_16x16x32_bf16 v[88:91], v[148:151], v[36:39], 0
    ds_read_b128 v[60:63], v6 offset:47104
    s_add_u32 s24, s24, 1
    s_cmp_eq_u32 s24, 7
    s_cselect_b32 s24, 0, s24
    s_mul_i32 s25, s24, 229376
    s_add_u32 s25, s25, s67
    s_lshl_b32 s26, s24, 7
    s_add_u32 s26, s26, s68
    s_lshl_b32 s3, s3, 7
    s_add_u32 s3, s3, 0x990000
    s_waitcnt lgkmcnt(5)
    v_mfma_f32_16x16x32_bf16 v[96:99], v[144:147], v[40:43], 0
    s_lshl_b32 s71, s71, 10
    v_cmp_eq_u32 vcc, 1, v0
    v_mov_b32 v28, 1792
    s_nop 0
    v_cndmask_b32 v17, v17, v28, vcc
    s_mov_b32 s44, s18
    s_mov_b32 s45, s19
    v_mfma_f32_16x16x32_bf16 v[104:107], v[148:151], v[40:43], 0
    s_mov_b32 s46, 0x188000
    s_mov_b32 s47, 0x20000
    s_waitcnt lgkmcnt(4)
    v_mfma_f32_16x16x32_bf16 v[112:115], v[144:147], v[44:47], 0
    s_mov_b32 s48, s10
    s_mov_b32 s49, s11
    s_mov_b32 s50, 0x62000
    v_mfma_f32_16x16x32_bf16 v[120:123], v[148:151], v[44:47], 0
    s_add_u32 m0, s8, 81920
    s_add_u32 s74, s26, s6
    buffer_load_dwordx4 v4, s[28:31], s74 offen lds
    s_mov_b32 s51, 0x20000
    s_mov_b32 s52, s22
    s_mov_b32 s53, s23
    s_waitcnt lgkmcnt(3)
    v_mfma_f32_16x16x32_bf16 v[68:71], v[144:147], v[48:51], 0
    ds_read_b64_tr_b16 v[152:153], v5 offset:8192
    ds_read_b64_tr_b16 v[154:155], v5 offset:9216
    s_mov_b32 s54, 0x1c0000
    s_mov_b32 s55, 0x20000
    v_mfma_f32_16x16x32_bf16 v[76:79], v[148:151], v[48:51], 0
    ds_read_b128 v[32:35], v7 offset:32768
    ds_read_b64_tr_b16 v[156:157], v5 offset:24576
    s_waitcnt lgkmcnt(6)
    v_mfma_f32_16x16x32_bf16 v[84:87], v[144:147], v[52:55], 0
    ds_read_b64_tr_b16 v[158:159], v5 offset:25600
    ds_read_b128 v[36:39], v7 offset:36864
    s_mul_i32 s63, s62, 37
    s_lshr_b32 s63, s63, 8
    s_mul_i32 s82, s63, 7
    v_mfma_f32_16x16x32_bf16 v[92:95], v[148:151], v[52:55], 0
    ds_read_b128 v[40:43], v7 offset:40960
    ds_read_b128 v[44:47], v7 offset:45056
    s_add_u32 m0, s8, 49152
    s_add_u32 s74, s25, s7
    buffer_load_dwordx4 v2, s[32:35], s74 offen lds
    s_waitcnt lgkmcnt(9)
    v_mfma_f32_16x16x32_bf16 v[100:103], v[144:147], v[56:59], 0
    s_sub_u32 s82, s62, s82
    s_mul_i32 s88, s82, 1
    s_mul_i32 s64, s63, 0
    v_mfma_f32_16x16x32_bf16 v[108:111], v[148:151], v[56:59], 0
    s_add_u32 m0, s8, 65536
    s_add_u32 s74, s25, s7
    buffer_load_dwordx4 v2, s[36:39], s74 offen lds
    s_add_u32 s88, s88, s64
    s_add_u32 s88, s88, s60
    s_and_b32 s88, s88, 7
    s_mul_i32 s64, s61, 3
    s_add_u32 s64, s64, s63
    s_waitcnt lgkmcnt(8)
    v_mfma_f32_16x16x32_bf16 v[116:119], v[144:147], v[60:63], 0
    s_sub_u32 s65, s64, 12
    s_cmp_eq_u32 s63, 3
    s_cselect_b32 s65, s61, s65
    s_cselect_b32 s64, 20, s64
    v_mfma_f32_16x16x32_bf16 v[124:127], v[148:151], v[60:63], 0
    s_add_u32 m0, s21, 81920
    s_add_u32 s74, s26, s9
    buffer_load_dwordx4 v4, s[28:31], s74 offen lds
    s_mul_i32 s80, s65, 6
    s_waitcnt lgkmcnt(5)
    v_mfma_f32_16x16x32_bf16 v[64:67], v[152:155], v[32:35], v[64:67]
    ds_read_b128 v[48:51], v7 offset:34816
    s_add_u32 s80, s80, 2
    s_lshl_b32 s66, s65, 1
    s_add_u32 s66, s66, 40
    s_waitcnt lgkmcnt(4)
    v_mfma_f32_16x16x32_bf16 v[72:75], v[156:159], v[32:35], v[72:75]
    ds_read_b128 v[52:55], v7 offset:38912
    s_cmp_ge_i32 s65, 10
    s_cselect_b32 s80, s66, s80
    s_lshr_b32 s65, s64, 1
    s_waitcnt lgkmcnt(4)
    v_mfma_f32_16x16x32_bf16 v[80:83], v[152:155], v[36:39], v[80:83]
    ds_read_b128 v[56:59], v7 offset:43008
    s_add_u32 m0, s21, 49152
    s_add_u32 s74, s25, s20
    buffer_load_dwordx4 v2, s[32:35], s74 offen lds
    s_mul_i32 s65, s65, 6
    s_and_b32 s66, s64, 1
    v_mfma_f32_16x16x32_bf16 v[88:91], v[156:159], v[36:39], v[88:91]
    ds_read_b128 v[60:63], v7 offset:47104
    s_add_u32 s65, s65, s66
    s_cmp_lt_u32 s64, 20
    s_cselect_b32 s80, s65, s80
    s_cselect_b32 s66, 4, 1
    s_waitcnt lgkmcnt(5)
    v_mfma_f32_16x16x32_bf16 v[96:99], v[152:155], v[40:43], v[96:99]
    s_add_u32 s81, s80, s66
    s_mul_i32 s4, s60, 6144
    v_mfma_f32_16x16x32_bf16 v[104:107], v[156:159], v[40:43], v[104:107]
    s_add_u32 m0, s21, 65536
    s_add_u32 s74, s25, s20
    buffer_load_dwordx4 v2, s[36:39], s74 offen lds
    s_lshl_b32 s27, s60, 13
    s_lshl_b32 s63, s82, 7
    s_waitcnt lgkmcnt(4)
    v_mfma_f32_16x16x32_bf16 v[112:115], v[152:155], v[44:47], v[112:115]
    s_mul_i32 s5, s88, 200704
    s_add_u32 s5, s5, s63
    s_mul_i32 s10, s88, 50176
    s_add_u32 s10, s10, s63
    s_cmp_ge_u32 s60, 4
    s_cselect_b32 s23, s81, s80
    v_mfma_f32_16x16x32_bf16 v[120:123], v[156:159], v[44:47], v[120:123]
    s_mul_i32 s23, s23, 28672
    s_add_u32 s23, s23, s63
    s_waitcnt vmcnt(6) lgkmcnt(0)
    s_barrier
    v_add_u32 v5, 0x18000, v5
    v_add_u32 v6, 0x18000, v6
    v_add_u32 v7, 0x18000, v7
    v_mfma_f32_16x16x32_bf16 v[68:71], v[152:155], v[48:51], v[68:71]
    ds_read_b64_tr_b16 v[160:161], v5 offset:0
    ds_read_b64_tr_b16 v[162:163], v5 offset:1024
    v_mfma_f32_16x16x32_bf16 v[76:79], v[156:159], v[48:51], v[76:79]
    ds_read_b128 v[32:35], v6 offset:32768
    ds_read_b64_tr_b16 v[164:165], v5 offset:16384
    s_and_b32 s63, s60, 3
    s_mul_i32 s63, s63, 7168
    v_mfma_f32_16x16x32_bf16 v[84:87], v[152:155], v[52:55], v[84:87]
    ds_read_b64_tr_b16 v[166:167], v5 offset:17408
    ds_read_b128 v[36:39], v6 offset:36864
    v_mfma_f32_16x16x32_bf16 v[92:95], v[156:159], v[52:55], v[92:95]
    ds_read_b128 v[40:43], v6 offset:40960
    ds_read_b128 v[44:47], v6 offset:45056
    s_add_u32 s23, s23, s63
    s_mul_i32 s63, s88, 14
    v_mfma_f32_16x16x32_bf16 v[100:103], v[152:155], v[56:59], v[100:103]
    s_mul_i32 s64, s80, 112
    s_add_u32 s64, s64, s63
    v_mfma_f32_16x16x32_bf16 v[108:111], v[156:159], v[56:59], v[108:111]
    s_add_u32 s24, s24, 1
    s_cmp_eq_u32 s24, 7
    s_cselect_b32 s24, 0, s24
    s_mul_i32 s25, s24, 229376
    s_add_u32 s25, s25, s67
    s_lshl_b32 s26, s24, 7
    s_add_u32 s26, s26, s68
    s_lshl_b32 s83, s64, 10
    s_mul_i32 s11, s80, 1792
    v_mfma_f32_16x16x32_bf16 v[116:119], v[152:155], v[60:63], v[116:119]
    s_add_u32 s11, s11, 0x990000
    s_lshl_b32 s64, s80, 3
    s_add_u32 s64, s64, s88
    s_lshl_b32 s85, s64, 12
    v_mfma_f32_16x16x32_bf16 v[124:127], v[156:159], v[60:63], v[124:127]
    s_add_u32 s85, s85, 0x700000
    s_mul_i32 s64, s81, 112
    s_waitcnt lgkmcnt(5)
    v_mfma_f32_16x16x32_bf16 v[64:67], v[160:163], v[32:35], v[64:67]
    ds_read_b128 v[48:51], v6 offset:34816
    s_add_u32 s64, s64, s63
    s_lshl_b32 s84, s64, 10
    s_waitcnt lgkmcnt(4)
    v_mfma_f32_16x16x32_bf16 v[72:75], v[164:167], v[32:35], v[72:75]
    ds_read_b128 v[52:55], v6 offset:38912
    s_mul_i32 s12, s81, 1792
    s_add_u32 s12, s12, 0x990000
    s_waitcnt lgkmcnt(4)
    v_mfma_f32_16x16x32_bf16 v[80:83], v[160:163], v[36:39], v[80:83]
    ds_read_b128 v[56:59], v6 offset:43008
    s_lshl_b32 s64, s81, 3
    s_add_u32 s64, s64, s88
    v_mfma_f32_16x16x32_bf16 v[88:91], v[164:167], v[36:39], v[88:91]
    ds_read_b128 v[60:63], v6 offset:47104
    s_add_u32 m0, s8, 32768
    s_add_u32 s74, s26, s6
    buffer_load_dwordx4 v4, s[28:31], s74 offen lds
    s_lshl_b32 s86, s64, 12
    s_add_u32 s86, s86, 0x700000
    s_waitcnt lgkmcnt(5)
    v_mfma_f32_16x16x32_bf16 v[96:99], v[160:163], v[40:43], v[96:99]
    v_lshlrev_b32 v13, 3, v0
    v_min_u32 v13, 13, v13
    v_mfma_f32_16x16x32_bf16 v[104:107], v[164:167], v[40:43], v[104:107]
    s_add_u32 m0, s8, 0
    s_add_u32 s74, s25, s7
    buffer_load_dwordx4 v2, s[32:35], s74 offen lds
    v_add_u32 v13, s63, v13
    s_lshl_b32 s63, s88, 7
    s_waitcnt lgkmcnt(4)
    v_mfma_f32_16x16x32_bf16 v[112:115], v[160:163], v[44:47], v[112:115]
    s_add_u32 s13, s63, 0x9ac000
    s_lshl_b32 s63, s80, 10
    v_mfma_f32_16x16x32_bf16 v[120:123], v[164:167], v[44:47], v[120:123]
    s_lshl_b32 s64, s81, 10
    v_mov_b32 v14, s64
    v_mov_b32 v28, s63
    v_cmp_eq_u32 vcc, 0, v0
    s_waitcnt lgkmcnt(3)
    v_mfma_f32_16x16x32_bf16 v[68:71], v[160:163], v[48:51], v[68:71]
    ds_read_b64_tr_b16 v[168:169], v5 offset:8192
    ds_read_b64_tr_b16 v[170:171], v5 offset:9216
    v_mfma_f32_16x16x32_bf16 v[76:79], v[164:167], v[48:51], v[76:79]
    ds_read_b128 v[32:35], v7 offset:32768
    ds_read_b64_tr_b16 v[172:173], v5 offset:24576
    s_add_u32 m0, s8, 16384
    s_add_u32 s74, s25, s7
    buffer_load_dwordx4 v2, s[36:39], s74 offen lds
    v_lshrrev_b32 v13, 3, v13
    v_lshlrev_b32 v13, 7, v13
    s_waitcnt lgkmcnt(6)
    v_mfma_f32_16x16x32_bf16 v[84:87], v[160:163], v[52:55], v[84:87]
    ds_read_b64_tr_b16 v[174:175], v5 offset:25600
    ds_read_b128 v[36:39], v7 offset:36864
    v_mfma_f32_16x16x32_bf16 v[92:95], v[164:167], v[52:55], v[92:95]
    ds_read_b128 v[40:43], v7 offset:40960
    ds_read_b128 v[44:47], v7 offset:45056
    v_cndmask_b32 v14, v14, v28, vcc
    v_bfe_u32 v28, v0, 4, 1
    s_waitcnt lgkmcnt(9)
    v_mfma_f32_16x16x32_bf16 v[100:103], v[160:163], v[56:59], v[100:103]
    v_lshlrev_b32 v28, 6, v28
    v_and_b32 v29, 0x70, v1
    v_mfma_f32_16x16x32_bf16 v[108:111], v[164:167], v[56:59], v[108:111]
    s_add_u32 m0, s21, 32768
    s_add_u32 s74, s26, s9
    buffer_load_dwordx4 v4, s[28:31], s74 offen lds
    v_xor_b32 v28, v28, v29
    v_lshrrev_b32 v29, 3, v0
    s_waitcnt lgkmcnt(8)
    v_mfma_f32_16x16x32_bf16 v[116:119], v[160:163], v[60:63], v[116:119]
    v_mul_u32_u24 v29, 896, v29
    v_add_u32 v10, v28, v29
    v_mfma_f32_16x16x32_bf16 v[124:127], v[164:167], v[60:63], v[124:127]
    v_bfe_u32 v28, v0, 2, 2
    v_lshrrev_b32 v29, 5, v0
    v_lshl_or_b32 v15, v29, 26, v10
    v_lshl_add_u32 v29, v29, 2, v28
    s_waitcnt lgkmcnt(5)
    v_mfma_f32_16x16x32_bf16 v[64:67], v[168:171], v[32:35], v[64:67]
    ds_read_b128 v[48:51], v7 offset:34816
    s_add_u32 m0, s21, 0
    s_add_u32 s74, s25, s20
    buffer_load_dwordx4 v2, s[32:35], s74 offen lds
    v_lshlrev_b32 v29, 7, v29
    v_bfe_u32 v28, v0, 3, 1
    s_waitcnt lgkmcnt(4)
    v_mfma_f32_16x16x32_bf16 v[72:75], v[172:175], v[32:35], v[72:75]
    ds_read_b128 v[52:55], v7 offset:38912
    v_lshl_add_u32 v29, v28, 6, v29
    v_bfe_u32 v28, v0, 4, 1
    s_waitcnt lgkmcnt(4)
    v_mfma_f32_16x16x32_bf16 v[80:83], v[168:171], v[36:39], v[80:83]
    ds_read_b128 v[56:59], v7 offset:43008
    v_mfma_f32_16x16x32_bf16 v[88:91], v[172:175], v[36:39], v[88:91]
    ds_read_b128 v[60:63], v7 offset:47104
    v_lshl_add_u32 v29, v28, 5, v29
    v_and_b32 v28, 1, v0
    s_waitcnt lgkmcnt(5)
    v_mfma_f32_16x16x32_bf16 v[96:99], v[168:171], v[40:43], v[96:99]
    s_add_u32 m0, s21, 16384
    s_add_u32 s74, s25, s20
    buffer_load_dwordx4 v2, s[36:39], s74 offen lds
    v_lshl_add_u32 v29, v28, 4, v29
    v_bfe_u32 v28, v0, 1, 1
    v_lshl_add_u32 v29, v28, 3, v29
    v_add_u32 v11, s4, v29
    v_mfma_f32_16x16x32_bf16 v[104:107], v[172:175], v[40:43], v[104:107]
    v_xor_b32 v12, 64, v11
    v_cmp_gt_u32 vcc, 3, v0
    s_waitcnt lgkmcnt(4)
    v_mfma_f32_16x16x32_bf16 v[112:115], v[168:171], v[44:47], v[112:115]
    v_mov_b32 v28, 0x4000000
    v_cndmask_b32 v13, v28, v13, vcc
    v_mfma_f32_16x16x32_bf16 v[120:123], v[172:175], v[44:47], v[120:123]
    v_cmp_gt_u32 vcc, 2, v0
    v_mov_b32 v28, 0x4000000
    s_nop 0
    v_cndmask_b32 v14, v28, v14, vcc
    s_waitcnt vmcnt(6) lgkmcnt(0)
    s_barrier
    v_add_u32 v5, 0xffff4000, v5
    v_add_u32 v6, 0xffff4000, v6
    v_add_u32 v7, 0xffff4000, v7
    v_mfma_f32_16x16x32_bf16 v[68:71], v[168:171], v[48:51], v[68:71]
    ds_read_b64_tr_b16 v[176:177], v5 offset:0
    ds_read_b64_tr_b16 v[178:179], v5 offset:1024
    v_mfma_f32_16x16x32_bf16 v[76:79], v[172:175], v[48:51], v[76:79]
    ds_read_b128 v[32:35], v6 offset:32768
    ds_read_b64_tr_b16 v[180:181], v5 offset:16384
    v_mfma_f32_16x16x32_bf16 v[84:87], v[168:171], v[52:55], v[84:87]
    ds_read_b64_tr_b16 v[182:183], v5 offset:17408
    ds_read_b128 v[36:39], v6 offset:36864
    v_mfma_f32_16x16x32_bf16 v[92:95], v[172:175], v[52:55], v[92:95]
    ds_read_b128 v[40:43], v6 offset:40960
    ds_read_b128 v[44:47], v6 offset:45056
    v_mfma_f32_16x16x32_bf16 v[100:103], v[168:171], v[56:59], v[100:103]
    v_mfma_f32_16x16x32_bf16 v[108:111], v[172:175], v[56:59], v[108:111]
    s_add_u32 s24, s24, 1
    s_cmp_eq_u32 s24, 7
    s_cselect_b32 s24, 0, s24
    s_mul_i32 s25, s24, 229376
    s_add_u32 s25, s25, s67
    s_lshl_b32 s26, s24, 7
    s_add_u32 s26, s26, s68
    v_mfma_f32_16x16x32_bf16 v[116:119], v[168:171], v[60:63], v[116:119]
    v_mfma_f32_16x16x32_bf16 v[124:127], v[172:175], v[60:63], v[124:127]
    s_waitcnt lgkmcnt(5)
    v_mfma_f32_16x16x32_bf16 v[64:67], v[176:179], v[32:35], v[64:67]
    ds_read_b128 v[48:51], v6 offset:34816
    s_waitcnt lgkmcnt(4)
    v_mfma_f32_16x16x32_bf16 v[72:75], v[180:183], v[32:35], v[72:75]
    ds_read_b128 v[52:55], v6 offset:38912
    s_waitcnt lgkmcnt(4)
    v_mfma_f32_16x16x32_bf16 v[80:83], v[176:179], v[36:39], v[80:83]
    ds_read_b128 v[56:59], v6 offset:43008
    v_mfma_f32_16x16x32_bf16 v[88:91], v[180:183], v[36:39], v[88:91]
    ds_read_b128 v[60:63], v6 offset:47104
    s_add_u32 m0, s8, 131072
    s_add_u32 s74, s26, s6
    buffer_load_dwordx4 v4, s[28:31], s74 offen lds
    s_waitcnt lgkmcnt(5)
    v_mfma_f32_16x16x32_bf16 v[96:99], v[176:179], v[40:43], v[96:99]
    v_mfma_f32_16x16x32_bf16 v[104:107], v[180:183], v[40:43], v[104:107]
    s_add_u32 m0, s8, 98304
    s_add_u32 s74, s25, s7
    buffer_load_dwordx4 v2, s[32:35], s74 offen lds
    s_waitcnt lgkmcnt(4)
    v_mfma_f32_16x16x32_bf16 v[112:115], v[176:179], v[44:47], v[112:115]
    v_mfma_f32_16x16x32_bf16 v[120:123], v[180:183], v[44:47], v[120:123]
    s_waitcnt lgkmcnt(3)
    v_mfma_f32_16x16x32_bf16 v[68:71], v[176:179], v[48:51], v[68:71]
    ds_read_b64_tr_b16 v[184:185], v5 offset:8192
    ds_read_b64_tr_b16 v[186:187], v5 offset:9216
    v_mfma_f32_16x16x32_bf16 v[76:79], v[180:183], v[48:51], v[76:79]
    ds_read_b128 v[32:35], v7 offset:32768
    ds_read_b64_tr_b16 v[188:189], v5 offset:24576
    s_add_u32 m0, s8, 114688
    s_add_u32 s74, s25, s7
    buffer_load_dwordx4 v2, s[36:39], s74 offen lds
    s_waitcnt lgkmcnt(6)
    v_mfma_f32_16x16x32_bf16 v[84:87], v[176:179], v[52:55], v[84:87]
    ds_read_b64_tr_b16 v[190:191], v5 offset:25600
    ds_read_b128 v[36:39], v7 offset:36864
    v_mfma_f32_16x16x32_bf16 v[92:95], v[180:183], v[52:55], v[92:95]
    ds_read_b128 v[40:43], v7 offset:40960
    ds_read_b128 v[44:47], v7 offset:45056
    s_waitcnt lgkmcnt(9)
    v_mfma_f32_16x16x32_bf16 v[100:103], v[176:179], v[56:59], v[100:103]
    v_mfma_f32_16x16x32_bf16 v[108:111], v[180:183], v[56:59], v[108:111]
    s_add_u32 m0, s21, 131072
    s_add_u32 s74, s26, s9
    buffer_load_dwordx4 v4, s[28:31], s74 offen lds
    s_waitcnt lgkmcnt(8)
    v_mfma_f32_16x16x32_bf16 v[116:119], v[176:179], v[60:63], v[116:119]
    v_mfma_f32_16x16x32_bf16 v[124:127], v[180:183], v[60:63], v[124:127]
    s_waitcnt lgkmcnt(5)
    v_mfma_f32_16x16x32_bf16 v[64:67], v[184:187], v[32:35], v[64:67]
    ds_read_b128 v[48:51], v7 offset:34816
    s_add_u32 m0, s21, 98304
    s_add_u32 s74, s25, s20
    buffer_load_dwordx4 v2, s[32:35], s74 offen lds
    s_waitcnt lgkmcnt(4)
    v_mfma_f32_16x16x32_bf16 v[72:75], v[188:191], v[32:35], v[72:75]
    ds_read_b128 v[52:55], v7 offset:38912
    s_waitcnt lgkmcnt(4)
    v_mfma_f32_16x16x32_bf16 v[80:83], v[184:187], v[36:39], v[80:83]
    ds_read_b128 v[56:59], v7 offset:43008
    v_mfma_f32_16x16x32_bf16 v[88:91], v[188:191], v[36:39], v[88:91]
    ds_read_b128 v[60:63], v7 offset:47104
    s_waitcnt lgkmcnt(5)
    v_mfma_f32_16x16x32_bf16 v[96:99], v[184:187], v[40:43], v[96:99]
    s_add_u32 m0, s21, 114688
    s_add_u32 s74, s25, s20
    buffer_load_dwordx4 v2, s[36:39], s74 offen lds
    v_mfma_f32_16x16x32_bf16 v[104:107], v[188:191], v[40:43], v[104:107]
    s_waitcnt lgkmcnt(4)
    v_mfma_f32_16x16x32_bf16 v[112:115], v[184:187], v[44:47], v[112:115]
    v_mfma_f32_16x16x32_bf16 v[120:123], v[188:191], v[44:47], v[120:123]
    s_waitcnt vmcnt(6) lgkmcnt(0)
    s_barrier
    v_add_u32 v5, 0xffff4000, v5
    v_add_u32 v6, 0xffff4000, v6
    v_add_u32 v7, 0xffff4000, v7
    v_mfma_f32_16x16x32_bf16 v[68:71], v[184:187], v[48:51], v[68:71]
    ds_read_b64_tr_b16 v[192:193], v5 offset:0
    ds_read_b64_tr_b16 v[194:195], v5 offset:1024
    v_mfma_f32_16x16x32_bf16 v[76:79], v[188:191], v[48:51], v[76:79]
    ds_read_b128 v[32:35], v6 offset:32768
    ds_read_b64_tr_b16 v[196:197], v5 offset:16384
    v_mfma_f32_16x16x32_bf16 v[84:87], v[184:187], v[52:55], v[84:87]
    ds_read_b64_tr_b16 v[198:199], v5 offset:17408
    ds_read_b128 v[36:39], v6 offset:36864
    v_mfma_f32_16x16x32_bf16 v[92:95], v[188:191], v[52:55], v[92:95]
    ds_read_b128 v[40:43], v6 offset:40960
    ds_read_b128 v[44:47], v6 offset:45056
    v_mfma_f32_16x16x32_bf16 v[100:103], v[184:187], v[56:59], v[100:103]
    v_mfma_f32_16x16x32_bf16 v[108:111], v[188:191], v[56:59], v[108:111]
    s_add_u32 s24, s24, 1
    s_cmp_eq_u32 s24, 7
    s_cselect_b32 s24, 0, s24
    s_mul_i32 s25, s24, 229376
    s_add_u32 s25, s25, s67
    s_lshl_b32 s26, s24, 7
    s_add_u32 s26, s26, s68
    v_mfma_f32_16x16x32_bf16 v[116:119], v[184:187], v[60:63], v[116:119]
    v_mfma_f32_16x16x32_bf16 v[124:127], v[188:191], v[60:63], v[124:127]
    s_waitcnt lgkmcnt(5)
    v_mfma_f32_16x16x32_bf16 v[64:67], v[192:195], v[32:35], v[64:67]
    ds_read_b128 v[48:51], v6 offset:34816
    s_waitcnt lgkmcnt(4)
    v_mfma_f32_16x16x32_bf16 v[72:75], v[196:199], v[32:35], v[72:75]
    ds_read_b128 v[52:55], v6 offset:38912
    s_waitcnt lgkmcnt(4)
    v_mfma_f32_16x16x32_bf16 v[80:83], v[192:195], v[36:39], v[80:83]
    ds_read_b128 v[56:59], v6 offset:43008
    v_mfma_f32_16x16x32_bf16 v[88:91], v[196:199], v[36:39], v[88:91]
    ds_read_b128 v[60:63], v6 offset:47104
    s_add_u32 m0, s8, 81920
    s_add_u32 s74, s26, s6
    buffer_load_dwordx4 v4, s[28:31], s74 offen lds
    s_waitcnt lgkmcnt(5)
    v_mfma_f32_16x16x32_bf16 v[96:99], v[192:195], v[40:43], v[96:99]
    v_mfma_f32_16x16x32_bf16 v[104:107], v[196:199], v[40:43], v[104:107]
    s_add_u32 m0, s8, 49152
    s_add_u32 s74, s25, s7
    buffer_load_dwordx4 v2, s[32:35], s74 offen lds
    s_waitcnt lgkmcnt(4)
    v_mfma_f32_16x16x32_bf16 v[112:115], v[192:195], v[44:47], v[112:115]
    v_mfma_f32_16x16x32_bf16 v[120:123], v[196:199], v[44:47], v[120:123]
    s_waitcnt lgkmcnt(3)
    v_mfma_f32_16x16x32_bf16 v[68:71], v[192:195], v[48:51], v[68:71]
    ds_read_b64_tr_b16 v[200:201], v5 offset:8192
    ds_read_b64_tr_b16 v[202:203], v5 offset:9216
    v_mfma_f32_16x16x32_bf16 v[76:79], v[196:199], v[48:51], v[76:79]
    ds_read_b128 v[32:35], v7 offset:32768
    ds_read_b64_tr_b16 v[204:205], v5 offset:24576
    s_add_u32 m0, s8, 65536
    s_add_u32 s74, s25, s7
    buffer_load_dwordx4 v2, s[36:39], s74 offen lds
    s_waitcnt lgkmcnt(6)
    v_mfma_f32_16x16x32_bf16 v[84:87], v[192:195], v[52:55], v[84:87]
    ds_read_b64_tr_b16 v[206:207], v5 offset:25600
    ds_read_b128 v[36:39], v7 offset:36864
    v_mfma_f32_16x16x32_bf16 v[92:95], v[196:199], v[52:55], v[92:95]
    ds_read_b128 v[40:43], v7 offset:40960
    ds_read_b128 v[44:47], v7 offset:45056
    s_waitcnt lgkmcnt(9)
    v_mfma_f32_16x16x32_bf16 v[100:103], v[192:195], v[56:59], v[100:103]
    v_mfma_f32_16x16x32_bf16 v[108:111], v[196:199], v[56:59], v[108:111]
    s_add_u32 m0, s21, 81920
    s_add_u32 s74, s26, s9
    buffer_load_dwordx4 v4, s[28:31], s74 offen lds
    s_waitcnt lgkmcnt(8)
    v_mfma_f32_16x16x32_bf16 v[116:119], v[192:195], v[60:63], v[116:119]
    v_mfma_f32_16x16x32_bf16 v[124:127], v[196:199], v[60:63], v[124:127]
    s_waitcnt lgkmcnt(5)
    v_mfma_f32_16x16x32_bf16 v[64:67], v[200:203], v[32:35], v[64:67]
    ds_read_b128 v[48:51], v7 offset:34816
    s_add_u32 m0, s21, 49152
    s_add_u32 s74, s25, s20
    buffer_load_dwordx4 v2, s[32:35], s74 offen lds
    s_waitcnt lgkmcnt(4)
    v_mfma_f32_16x16x32_bf16 v[72:75], v[204:207], v[32:35], v[72:75]
    ds_read_b128 v[52:55], v7 offset:38912
    s_waitcnt lgkmcnt(4)
    v_mfma_f32_16x16x32_bf16 v[80:83], v[200:203], v[36:39], v[80:83]
    ds_read_b128 v[56:59], v7 offset:43008
    v_mfma_f32_16x16x32_bf16 v[88:91], v[204:207], v[36:39], v[88:91]
    ds_read_b128 v[60:63], v7 offset:47104
    s_waitcnt lgkmcnt(5)
    v_mfma_f32_16x16x32_bf16 v[96:99], v[200:203], v[40:43], v[96:99]
    s_add_u32 m0, s21, 65536
    s_add_u32 s74, s25, s20
    buffer_load_dwordx4 v2, s[36:39], s74 offen lds
    v_mfma_f32_16x16x32_bf16 v[104:107], v[204:207], v[40:43], v[104:107]
    s_waitcnt lgkmcnt(4)
    v_mfma_f32_16x16x32_bf16 v[112:115], v[200:203], v[44:47], v[112:115]
    v_mfma_f32_16x16x32_bf16 v[120:123], v[204:207], v[44:47], v[120:123]
    s_waitcnt vmcnt(6) lgkmcnt(0)
    s_barrier
    v_add_u32 v5, 0x18000, v5
    v_add_u32 v6, 0x18000, v6
    v_add_u32 v7, 0x18000, v7
    v_lshrrev_b32 v19, 3, v0
    v_lshlrev_b32 v19, 8, v19
    v_lshl_add_u32 v19, v0, 2, v19
    buffer_load_dword v16, v19, s[56:59], 0 offen sc1
    v_mfma_f32_16x16x32_bf16 v[68:71], v[200:203], v[48:51], v[68:71]
    ds_read_b64_tr_b16 v[208:209], v5 offset:0
    ds_read_b64_tr_b16 v[210:211], v5 offset:1024
    v_mfma_f32_16x16x32_bf16 v[76:79], v[204:207], v[48:51], v[76:79]
    ds_read_b128 v[32:35], v6 offset:32768
    ds_read_b64_tr_b16 v[212:213], v5 offset:16384
    v_mfma_f32_16x16x32_bf16 v[84:87], v[200:203], v[52:55], v[84:87]
    ds_read_b64_tr_b16 v[214:215], v5 offset:17408
    ds_read_b128 v[36:39], v6 offset:36864
    v_mfma_f32_16x16x32_bf16 v[92:95], v[204:207], v[52:55], v[92:95]
    ds_read_b128 v[40:43], v6 offset:40960
    ds_read_b128 v[44:47], v6 offset:45056
    v_mfma_f32_16x16x32_bf16 v[100:103], v[200:203], v[56:59], v[100:103]
    v_mfma_f32_16x16x32_bf16 v[108:111], v[204:207], v[56:59], v[108:111]
    s_add_u32 s24, s24, 1
    s_cmp_eq_u32 s24, 7
    s_cselect_b32 s24, 0, s24
    s_mul_i32 s25, s24, 229376
    s_add_u32 s25, s25, s67
    s_lshl_b32 s26, s24, 7
    s_add_u32 s26, s26, s68
    v_mfma_f32_16x16x32_bf16 v[116:119], v[200:203], v[60:63], v[116:119]
    v_mfma_f32_16x16x32_bf16 v[124:127], v[204:207], v[60:63], v[124:127]
    s_waitcnt lgkmcnt(5)
    v_mfma_f32_16x16x32_bf16 v[64:67], v[208:211], v[32:35], v[64:67]
    ds_read_b128 v[48:51], v6 offset:34816
    s_waitcnt lgkmcnt(4)
    v_mfma_f32_16x16x32_bf16 v[72:75], v[212:215], v[32:35], v[72:75]
    ds_read_b128 v[52:55], v6 offset:38912
    s_waitcnt lgkmcnt(4)
    v_mfma_f32_16x16x32_bf16 v[80:83], v[208:211], v[36:39], v[80:83]
    ds_read_b128 v[56:59], v6 offset:43008
    v_mfma_f32_16x16x32_bf16 v[88:91], v[212:215], v[36:39], v[88:91]
    ds_read_b128 v[60:63], v6 offset:47104
    s_add_u32 m0, s8, 32768
    s_add_u32 s74, s26, s6
    buffer_load_dwordx4 v4, s[28:31], s74 offen lds
    s_waitcnt lgkmcnt(5)
    v_mfma_f32_16x16x32_bf16 v[96:99], v[208:211], v[40:43], v[96:99]
    v_mfma_f32_16x16x32_bf16 v[104:107], v[212:215], v[40:43], v[104:107]
    s_add_u32 m0, s8, 0
    s_add_u32 s74, s25, s7
    buffer_load_dwordx4 v2, s[32:35], s74 offen lds
    s_waitcnt lgkmcnt(4)
    v_mfma_f32_16x16x32_bf16 v[112:115], v[208:211], v[44:47], v[112:115]
    v_mfma_f32_16x16x32_bf16 v[120:123], v[212:215], v[44:47], v[120:123]
    s_waitcnt lgkmcnt(3)
    v_mfma_f32_16x16x32_bf16 v[68:71], v[208:211], v[48:51], v[68:71]
    ds_read_b64_tr_b16 v[216:217], v5 offset:8192
    ds_read_b64_tr_b16 v[218:219], v5 offset:9216
    v_mfma_f32_16x16x32_bf16 v[76:79], v[212:215], v[48:51], v[76:79]
    ds_read_b128 v[32:35], v7 offset:32768
    ds_read_b64_tr_b16 v[220:221], v5 offset:24576
    s_add_u32 m0, s8, 16384
    s_add_u32 s74, s25, s7
    buffer_load_dwordx4 v2, s[36:39], s74 offen lds
    s_waitcnt lgkmcnt(6)
    v_mfma_f32_16x16x32_bf16 v[84:87], v[208:211], v[52:55], v[84:87]
    ds_read_b64_tr_b16 v[222:223], v5 offset:25600
    ds_read_b128 v[36:39], v7 offset:36864
    v_mfma_f32_16x16x32_bf16 v[92:95], v[212:215], v[52:55], v[92:95]
    ds_read_b128 v[40:43], v7 offset:40960
    ds_read_b128 v[44:47], v7 offset:45056
    s_waitcnt lgkmcnt(9)
    v_mfma_f32_16x16x32_bf16 v[100:103], v[208:211], v[56:59], v[100:103]
    v_mfma_f32_16x16x32_bf16 v[108:111], v[212:215], v[56:59], v[108:111]
    s_add_u32 m0, s21, 32768
    s_add_u32 s74, s26, s9
    buffer_load_dwordx4 v4, s[28:31], s74 offen lds
    s_waitcnt lgkmcnt(8)
    v_mfma_f32_16x16x32_bf16 v[116:119], v[208:211], v[60:63], v[116:119]
    v_mfma_f32_16x16x32_bf16 v[124:127], v[212:215], v[60:63], v[124:127]
    s_waitcnt lgkmcnt(5)
    v_mfma_f32_16x16x32_bf16 v[64:67], v[216:219], v[32:35], v[64:67]
    ds_read_b128 v[48:51], v7 offset:34816
    s_add_u32 m0, s21, 0
    s_add_u32 s74, s25, s20
    buffer_load_dwordx4 v2, s[32:35], s74 offen lds
    s_waitcnt lgkmcnt(4)
    v_mfma_f32_16x16x32_bf16 v[72:75], v[220:223], v[32:35], v[72:75]
    ds_read_b128 v[52:55], v7 offset:38912
    s_waitcnt lgkmcnt(4)
    v_mfma_f32_16x16x32_bf16 v[80:83], v[216:219], v[36:39], v[80:83]
    ds_read_b128 v[56:59], v7 offset:43008
    v_mfma_f32_16x16x32_bf16 v[88:91], v[220:223], v[36:39], v[88:91]
    ds_read_b128 v[60:63], v7 offset:47104
    s_waitcnt lgkmcnt(5)
    v_mfma_f32_16x16x32_bf16 v[96:99], v[216:219], v[40:43], v[96:99]
    s_add_u32 m0, s21, 16384
    s_add_u32 s74, s25, s20
    buffer_load_dwordx4 v2, s[36:39], s74 offen lds
    v_mfma_f32_16x16x32_bf16 v[104:107], v[220:223], v[40:43], v[104:107]
    s_waitcnt lgkmcnt(4)
    v_mfma_f32_16x16x32_bf16 v[112:115], v[216:219], v[44:47], v[112:115]
    v_mfma_f32_16x16x32_bf16 v[120:123], v[220:223], v[44:47], v[120:123]
    s_waitcnt vmcnt(7) lgkmcnt(0)
    s_barrier
    v_add_u32 v5, 0xffff4000, v5
    v_add_u32 v6, 0xffff4000, v6
    v_add_u32 v7, 0xffff4000, v7
    v_mfma_f32_16x16x32_bf16 v[68:71], v[216:219], v[48:51], v[68:71]
    ds_read_b64_tr_b16 v[224:225], v5 offset:0
    ds_read_b64_tr_b16 v[226:227], v5 offset:1024
    v_mfma_f32_16x16x32_bf16 v[76:79], v[220:223], v[48:51], v[76:79]
    ds_read_b128 v[32:35], v6 offset:32768
    ds_read_b64_tr_b16 v[228:229], v5 offset:16384
    v_mfma_f32_16x16x32_bf16 v[84:87], v[216:219], v[52:55], v[84:87]
    ds_read_b64_tr_b16 v[230:231], v5 offset:17408
    ds_read_b128 v[36:39], v6 offset:36864
    s_add_u32 s24, s24, 1
    s_cmp_eq_u32 s24, 7
    s_cselect_b32 s24, 0, s24
    s_lshl_b32 s26, s24, 7
    s_add_u32 s26, s26, s68
    v_mfma_f32_16x16x32_bf16 v[92:95], v[220:223], v[52:55], v[92:95]
    ds_read_b128 v[40:43], v6 offset:40960
    ds_read_b128 v[44:47], v6 offset:45056
    v_mfma_f32_16x16x32_bf16 v[100:103], v[216:219], v[56:59], v[100:103]
    v_mfma_f32_16x16x32_bf16 v[108:111], v[220:223], v[56:59], v[108:111]
    s_add_u32 m0, s69, 98304
    s_add_u32 s74, s26, 114688
    buffer_load_dwordx4 v4, s[28:31], s74 offen lds
    v_mfma_f32_16x16x32_bf16 v[116:119], v[216:219], v[60:63], v[116:119]
    s_add_u32 s24, s24, 1
    s_cmp_eq_u32 s24, 7
    s_cselect_b32 s24, 0, s24
    s_lshl_b32 s26, s24, 7
    s_add_u32 s26, s26, s68
    v_mfma_f32_16x16x32_bf16 v[124:127], v[220:223], v[60:63], v[124:127]
    s_waitcnt lgkmcnt(5)
    v_mfma_f32_16x16x32_bf16 v[64:67], v[224:227], v[32:35], v[64:67]
    ds_read_b128 v[48:51], v6 offset:34816
    s_add_u32 m0, s69, 106496
    s_add_u32 s74, s26, 114688
    buffer_load_dwordx4 v4, s[28:31], s74 offen lds
    s_waitcnt lgkmcnt(4)
    v_mfma_f32_16x16x32_bf16 v[72:75], v[228:231], v[32:35], v[72:75]
    ds_read_b128 v[52:55], v6 offset:38912
    s_waitcnt lgkmcnt(4)
    v_mfma_f32_16x16x32_bf16 v[80:83], v[224:227], v[36:39], v[80:83]
    ds_read_b128 v[56:59], v6 offset:43008
    s_add_u32 s24, s24, 1
    s_cmp_eq_u32 s24, 7
    s_cselect_b32 s24, 0, s24
    s_lshl_b32 s26, s24, 7
    s_add_u32 s26, s26, s68
    v_mfma_f32_16x16x32_bf16 v[88:91], v[228:231], v[36:39], v[88:91]
    ds_read_b128 v[60:63], v6 offset:47104
    s_waitcnt lgkmcnt(5)
    v_mfma_f32_16x16x32_bf16 v[96:99], v[224:227], v[40:43], v[96:99]
    s_add_u32 m0, s69, 114688
    s_add_u32 s74, s26, 114688
    buffer_load_dwordx4 v4, s[28:31], s74 offen lds
    v_mfma_f32_16x16x32_bf16 v[104:107], v[228:231], v[40:43], v[104:107]
    s_waitcnt lgkmcnt(4)
    v_mfma_f32_16x16x32_bf16 v[112:115], v[224:227], v[44:47], v[112:115]
    s_add_u32 s24, s24, 1
    s_cmp_eq_u32 s24, 7
    s_cselect_b32 s24, 0, s24
    s_lshl_b32 s26, s24, 7
    s_add_u32 s26, s26, s68
    v_mfma_f32_16x16x32_bf16 v[120:123], v[228:231], v[44:47], v[120:123]
    s_add_u32 m0, s69, 122880
    s_add_u32 s74, s26, 114688
    buffer_load_dwordx4 v4, s[28:31], s74 offen lds
    s_waitcnt lgkmcnt(3)
    v_mfma_f32_16x16x32_bf16 v[68:71], v[224:227], v[48:51], v[68:71]
    ds_read_b64_tr_b16 v[232:233], v5 offset:8192
    ds_read_b64_tr_b16 v[234:235], v5 offset:9216
    v_mfma_f32_16x16x32_bf16 v[76:79], v[228:231], v[48:51], v[76:79]
    ds_read_b128 v[32:35], v7 offset:32768
    ds_read_b64_tr_b16 v[236:237], v5 offset:24576
    s_waitcnt lgkmcnt(6)
    v_mfma_f32_16x16x32_bf16 v[84:87], v[224:227], v[52:55], v[84:87]
    ds_read_b64_tr_b16 v[238:239], v5 offset:25600
    ds_read_b128 v[36:39], v7 offset:36864
    v_mfma_f32_16x16x32_bf16 v[92:95], v[228:231], v[52:55], v[92:95]
    ds_read_b128 v[40:43], v7 offset:40960
    ds_read_b128 v[44:47], v7 offset:45056
    s_add_u32 s24, s24, 1
    s_cmp_eq_u32 s24, 7
    s_cselect_b32 s24, 0, s24
    s_lshl_b32 s26, s24, 7
    s_add_u32 s26, s26, s68
    s_waitcnt lgkmcnt(9)
    v_mfma_f32_16x16x32_bf16 v[100:103], v[224:227], v[56:59], v[100:103]
    v_mfma_f32_16x16x32_bf16 v[108:111], v[228:231], v[56:59], v[108:111]
    s_add_u32 m0, s69, 131072
    s_add_u32 s74, s26, 114688
    buffer_load_dwordx4 v4, s[28:31], s74 offen lds
    s_waitcnt lgkmcnt(8)
    v_mfma_f32_16x16x32_bf16 v[116:119], v[224:227], v[60:63], v[116:119]
    v_mfma_f32_16x16x32_bf16 v[124:127], v[228:231], v[60:63], v[124:127]
    s_add_u32 s24, s24, 1
    s_cmp_eq_u32 s24, 7
    s_cselect_b32 s24, 0, s24
    s_lshl_b32 s26, s24, 7
    s_add_u32 s26, s26, s68
    s_waitcnt lgkmcnt(5)
    v_mfma_f32_16x16x32_bf16 v[64:67], v[232:235], v[32:35], v[64:67]
    ds_read_b128 v[48:51], v7 offset:34816
    s_add_u32 m0, s69, 139264
    s_add_u32 s74, s26, 114688
    buffer_load_dwordx4 v4, s[28:31], s74 offen lds
    s_waitcnt lgkmcnt(4)
    v_mfma_f32_16x16x32_bf16 v[72:75], v[236:239], v[32:35], v[72:75]
    ds_read_b128 v[52:55], v7 offset:38912
    s_waitcnt lgkmcnt(4)
    v_mfma_f32_16x16x32_bf16 v[80:83], v[232:235], v[36:39], v[80:83]
    ds_read_b128 v[56:59], v7 offset:43008
    v_mfma_f32_16x16x32_bf16 v[88:91], v[236:239], v[36:39], v[88:91]
    ds_read_b128 v[60:63], v7 offset:47104
    s_add_u32 s24, s24, 1
    s_cmp_eq_u32 s24, 7
    s_cselect_b32 s24, 0, s24
    s_lshl_b32 s26, s24, 7
    s_add_u32 s26, s26, s68
    s_waitcnt lgkmcnt(5)
    v_mfma_f32_16x16x32_bf16 v[96:99], v[232:235], v[40:43], v[96:99]
    v_mfma_f32_16x16x32_bf16 v[104:107], v[236:239], v[40:43], v[104:107]
    s_add_u32 m0, s69, 147456
    s_add_u32 s74, s26, 114688
    buffer_load_dwordx4 v4, s[28:31], s74 offen lds
    s_waitcnt lgkmcnt(4)
    v_mfma_f32_16x16x32_bf16 v[112:115], v[232:235], v[44:47], v[112:115]
    v_mfma_f32_16x16x32_bf16 v[120:123], v[236:239], v[44:47], v[120:123]
    s_waitcnt vmcnt(7) lgkmcnt(0)
    s_barrier
    v_add_u32 v5, 0xffff4000, v5
    v_add_u32 v6, 0xffff4000, v6
    v_add_u32 v7, 0xffff4000, v7
    v_cmp_eq_u32 vcc, 0, v16
    s_nop 1
    s_and_b32 s74, vcc_lo, 63
    s_cbranch_scc0 L_ok1
    s_mov_b32 s75, 40000
L_sp1:
    s_sleep 2
    buffer_load_dword v16, v19, s[56:59], 0 offen sc1
    s_waitcnt vmcnt(0)
    v_cmp_eq_u32 vcc, 0, v16
    s_sub_u32 s75, s75, 1
    s_cmp_eq_u32 s75, 0
    s_cbranch_scc1 L_ok1
    s_and_b32 s74, vcc_lo, 63
    s_cbranch_scc1 L_sp1
L_ok1:
    v_lshlrev_b32 v19, 2, v0
    v_add_u32 v19, 155648, v19
    v_mfma_f32_16x16x32_bf16 v[68:71], v[232:235], v[48:51], v[68:71]
    ds_read_b64_tr_b16 v[240:241], v5 offset:0
    ds_read_b64_tr_b16 v[242:243], v5 offset:1024
    v_mfma_f32_16x16x32_bf16 v[76:79], v[236:239], v[48:51], v[76:79]
    ds_read_b128 v[32:35], v6 offset:32768
    ds_read_b64_tr_b16 v[244:245], v5 offset:16384
    v_mfma_f32_16x16x32_bf16 v[84:87], v[232:235], v[52:55], v[84:87]
    ds_read_b64_tr_b16 v[246:247], v5 offset:17408
    ds_read_b128 v[36:39], v6 offset:36864
    v_mfma_f32_16x16x32_bf16 v[92:95], v[236:239], v[52:55], v[92:95]
    ds_read_b128 v[40:43], v6 offset:40960
    ds_read_b128 v[44:47], v6 offset:45056
    v_mfma_f32_16x16x32_bf16 v[100:103], v[232:235], v[56:59], v[100:103]
    s_add_u32 m0, s4, 49152
    s_add_u32 s74, s5, 0
    buffer_load_dwordx4 v10, s[44:47], s74 offen lds
    v_mfma_f32_16x16x32_bf16 v[108:111], v[236:239], v[56:59], v[108:111]
    v_mfma_f32_16x16x32_bf16 v[116:119], v[232:235], v[60:63], v[116:119]
    v_mfma_f32_16x16x32_bf16 v[124:127], v[236:239], v[60:63], v[124:127]
    s_waitcnt lgkmcnt(5)
    v_mfma_f32_16x16x32_bf16 v[64:67], v[240:243], v[32:35], v[64:67]
    ds_read_b128 v[48:51], v6 offset:34816
    s_add_u32 m0, s4, 50176
    s_add_u32 s74, s5, 7168
    buffer_load_dwordx4 v10, s[44:47], s74 offen lds
    s_waitcnt lgkmcnt(4)
    v_mfma_f32_16x16x32_bf16 v[72:75], v[244:247], v[32:35], v[72:75]
    ds_read_b128 v[52:55], v6 offset:38912
    s_waitcnt lgkmcnt(4)
    v_mfma_f32_16x16x32_bf16 v[80:83], v[240:243], v[36:39], v[80:83]
    ds_read_b128 v[56:59], v6 offset:43008
    v_mfma_f32_16x16x32_bf16 v[88:91], v[244:247], v[36:39], v[88:91]
    ds_read_b128 v[60:63], v6 offset:47104
    s_waitcnt lgkmcnt(5)
    v_mfma_f32_16x16x32_bf16 v[96:99], v[240:243], v[40:43], v[96:99]
    s_add_u32 m0, s4, 51200
    s_add_u32 s74, s5, 14336
    buffer_load_dwordx4 v10, s[44:47], s74 offen lds
    v_mfma_f32_16x16x32_bf16 v[104:107], v[244:247], v[40:43], v[104:107]
    s_waitcnt lgkmcnt(4)
    v_mfma_f32_16x16x32_bf16 v[112:115], v[240:243], v[44:47], v[112:115]
    v_mfma_f32_16x16x32_bf16 v[120:123], v[244:247], v[44:47], v[120:123]
    s_waitcnt lgkmcnt(3)
    v_mfma_f32_16x16x32_bf16 v[68:71], v[240:243], v[48:51], v[68:71]
    ds_read_b64_tr_b16 v[248:249], v5 offset:8192
    ds_read_b64_tr_b16 v[250:251], v5 offset:9216
    v_mfma_f32_16x16x32_bf16 v[76:79], v[244:247], v[48:51], v[76:79]
    ds_read_b128 v[32:35], v7 offset:32768
    ds_read_b64_tr_b16 v[252:253], v5 offset:24576
    s_add_u32 m0, s4, 52224
    s_add_u32 s74, s5, 21504
    buffer_load_dwordx4 v10, s[44:47], s74 offen lds
    s_waitcnt lgkmcnt(6)
    v_mfma_f32_16x16x32_bf16 v[84:87], v[240:243], v[52:55], v[84:87]
    ds_read_b64_tr_b16 v[254:255], v5 offset:25600
    ds_read_b128 v[36:39], v7 offset:36864
    v_mfma_f32_16x16x32_bf16 v[92:95], v[244:247], v[52:55], v[92:95]
    ds_read_b128 v[40:43], v7 offset:40960
    ds_read_b128 v[44:47], v7 offset:45056
    s_waitcnt lgkmcnt(9)
    v_mfma_f32_16x16x32_bf16 v[100:103], v[240:243], v[56:59], v[100:103]
    v_mfma_f32_16x16x32_bf16 v[108:111], v[244:247], v[56:59], v[108:111]
    s_waitcnt lgkmcnt(8)
    v_mfma_f32_16x16x32_bf16 v[116:119], v[240:243], v[60:63], v[116:119]
    s_add_u32 m0, s4, 53248
    s_add_u32 s74, s5, 28672
    buffer_load_dwordx4 v10, s[44:47], s74 offen lds
    v_mfma_f32_16x16x32_bf16 v[124:127], v[244:247], v[60:63], v[124:127]
    s_waitcnt lgkmcnt(5)
    v_mfma_f32_16x16x32_bf16 v[64:67], v[248:251], v[32:35], v[64:67]
    ds_read_b128 v[48:51], v7 offset:34816
    s_waitcnt lgkmcnt(4)
    v_mfma_f32_16x16x32_bf16 v[72:75], v[252:255], v[32:35], v[72:75]
    ds_read_b128 v[52:55], v7 offset:38912
    s_waitcnt lgkmcnt(4)
    v_mfma_f32_16x16x32_bf16 v[80:83], v[248:251], v[36:39], v[80:83]
    ds_read_b128 v[56:59], v7 offset:43008
    v_mfma_f32_16x16x32_bf16 v[88:91], v[252:255], v[36:39], v[88:91]
    ds_read_b128 v[60:63], v7 offset:47104
    s_add_u32 m0, s4, 54272
    s_add_u32 s74, s5, 35840
    buffer_load_dwordx4 v10, s[44:47], s74 offen lds
    s_waitcnt lgkmcnt(5)
    v_mfma_f32_16x16x32_bf16 v[96:99], v[248:251], v[40:43], v[96:99]
    v_mfma_f32_16x16x32_bf16 v[104:107], v[252:255], v[40:43], v[104:107]
    s_waitcnt lgkmcnt(4)
    v_mfma_f32_16x16x32_bf16 v[112:115], v[248:251], v[44:47], v[112:115]
    v_mfma_f32_16x16x32_bf16 v[120:123], v[252:255], v[44:47], v[120:123]
    s_waitcnt vmcnt(6) lgkmcnt(0)
    s_barrier
    v_add_u32 v6, 0x18000, v6
    v_add_u32 v7, 0x18000, v7
    v_mfma_f32_16x16x32_bf16 v[68:71], v[248:251], v[48:51], v[68:71]
    ds_read_b128 v[32:35], v6 offset:0
    v_mfma_f32_16x16x32_bf16 v[76:79], v[252:255], v[48:51], v[76:79]
    ds_read_b128 v[36:39], v6 offset:2048
    v_mfma_f32_16x16x32_bf16 v[84:87], v[248:251], v[52:55], v[84:87]
    ds_read_b128 v[40:43], v7 offset:0
    v_mfma_f32_16x16x32_bf16 v[92:95], v[252:255], v[52:55], v[92:95]
    ds_read_b128 v[44:47], v7 offset:2048
    v_mfma_f32_16x16x32_bf16 v[100:103], v[248:251], v[56:59], v[100:103]
    v_mfma_f32_16x16x32_bf16 v[108:111], v[252:255], v[56:59], v[108:111]
    v_mfma_f32_16x16x32_bf16 v[116:119], v[248:251], v[60:63], v[116:119]
    v_mfma_f32_16x16x32_bf16 v[124:127], v[252:255], v[60:63], v[124:127]
    s_cmp_eq_u32 s72, 10
    s_cbranch_scc1 L_ffn_short
    s_waitcnt lgkmcnt(3)
    v_mfma_f32_16x16x32_bf16 v[128:131], v[144:147], v[32:35], 0
    v_mfma_f32_16x16x32_bf16 v[136:139], v[148:151], v[32:35], 0
    ds_read_b128 v[48:51], v6 offset:8192
    s_add_u32 m0, s4, 0
    s_add_u32 s74, s5, 43008
    buffer_load_dwordx4 v10, s[44:47], s74 offen lds
    s_waitcnt lgkmcnt(3)
    v_mfma_f32_16x16x32_bf16 v[132:135], v[144:147], v[36:39], 0
    v_mul_f32 v88, v80, v88
    v_mul_f32_e64 v80, -s70, v80
    v_exp_f32 v80, v80
    v_mfma_f32_16x16x32_bf16 v[140:143], v[148:151], v[36:39], 0
    v_mul_f32 v89, v81, v89
    v_mul_f32_e64 v81, -s70, v81
    ds_read_b128 v[52:55], v6 offset:10240
    s_waitcnt lgkmcnt(3)
    v_mfma_f32_16x16x32_bf16 v[128:131], v[152:155], v[40:43], v[128:131]
    v_add_f32 v80, 1.0, v80
    v_exp_f32 v81, v81
    v_mfma_f32_16x16x32_bf16 v[136:139], v[156:159], v[40:43], v[136:139]
    v_rcp_f32 v80, v80
    v_mul_f32 v90, v82, v90
    v_mul_f32_e64 v82, -s70, v82
    ds_read_b128 v[56:59], v7 offset:8192
    s_add_u32 m0, s4, 1024
    s_add_u32 s74, s5, 50176
    buffer_load_dwordx4 v10, s[44:47], s74 offen lds
    s_waitcnt lgkmcnt(3)
    v_mfma_f32_16x16x32_bf16 v[132:135], v[152:155], v[44:47], v[132:135]
    v_add_f32 v81, 1.0, v81
    v_exp_f32 v82, v82
    v_mfma_f32_16x16x32_bf16 v[140:143], v[156:159], v[44:47], v[140:143]
    v_mul_f32 v88, v88, v80
    v_rcp_f32 v81, v81
    ds_read_b128 v[60:63], v7 offset:10240
    s_waitcnt lgkmcnt(3)
    v_mfma_f32_16x16x32_bf16 v[128:131], v[160:163], v[48:51], v[128:131]
    v_mul_f32 v91, v83, v91
    v_mul_f32_e64 v83, -s70, v83
    v_add_f32 v82, 1.0, v82
    v_mfma_f32_16x16x32_bf16 v[136:139], v[164:167], v[48:51], v[136:139]
    v_exp_f32 v83, v83
    v_mul_f32 v89, v89, v81
    ds_read_b128 v[32:35], v6 offset:16384
    s_add_u32 m0, s4, 2048
    s_add_u32 s74, s5, 57344
    buffer_load_dwordx4 v10, s[44:47], s74 offen lds
    s_waitcnt lgkmcnt(3)
    v_mfma_f32_16x16x32_bf16 v[132:135], v[160:163], v[52:55], v[132:135]
    v_rcp_f32 v82, v82
    v_cvt_pk_bf16_f32 v2, v88, v89
    v_mul_f32 v92, v84, v92
    v_mfma_f32_16x16x32_bf16 v[140:143], v[164:167], v[52:55], v[140:143]
    v_mul_f32_e64 v84, -s70, v84
    v_add_f32 v83, 1.0, v83
    ds_read_b128 v[36:39], v6 offset:18432
    s_waitcnt lgkmcnt(3)
    v_mfma_f32_16x16x32_bf16 v[128:131], v[168:171], v[56:59], v[128:131]
    v_exp_f32 v84, v84
    v_mul_f32 v90, v90, v82
    v_mfma_f32_16x16x32_bf16 v[136:139], v[172:175], v[56:59], v[136:139]
    v_rcp_f32 v83, v83
    v_mul_f32 v93, v85, v93
    v_mul_f32_e64 v85, -s70, v85
    ds_read_b128 v[40:43], v7 offset:16384
    s_add_u32 m0, s4, 3072
    s_add_u32 s74, s5, 64512
    buffer_load_dwordx4 v10, s[44:47], s74 offen lds
    s_waitcnt lgkmcnt(3)
    v_mfma_f32_16x16x32_bf16 v[132:135], v[168:171], v[60:63], v[132:135]
    v_add_f32 v84, 1.0, v84
    v_exp_f32 v85, v85
    v_mfma_f32_16x16x32_bf16 v[140:143], v[172:175], v[60:63], v[140:143]
    v_mul_f32 v91, v91, v83
    v_rcp_f32 v84, v84
    v_cvt_pk_bf16_f32 v3, v90, v91
    ds_read_b128 v[44:47], v7 offset:18432
    s_waitcnt vmcnt(8)
    ds_read_b64_tr_b16 v[20:21], v11 offset:49152
    ds_read_b64_tr_b16 v[22:23], v11 offset:50176
    ds_read_b64_tr_b16 v[24:25], v12 offset:49152
    ds_read_b64_tr_b16 v[26:27], v12 offset:50176
    s_waitcnt lgkmcnt(7)
    v_mfma_f32_16x16x32_bf16 v[128:131], v[176:179], v[32:35], v[128:131]
    v_mul_f32 v94, v86, v94
    v_mul_f32_e64 v86, -s70, v86
    v_add_f32 v85, 1.0, v85
    v_mfma_f32_16x16x32_bf16 v[136:139], v[180:183], v[32:35], v[136:139]
    v_exp_f32 v86, v86
    v_mul_f32 v92, v92, v84
    ds_read_b128 v[48:51], v6 offset:24576
    s_add_u32 m0, s4, 4096
    s_add_u32 s74, s5, 71680
    buffer_load_dwordx4 v10, s[44:47], s74 offen lds
    s_waitcnt lgkmcnt(7)
    v_mfma_f32_16x16x32_bf16 v[132:135], v[176:179], v[36:39], v[132:135]
    v_rcp_f32 v85, v85
    v_mul_f32 v95, v87, v95
    v_mfma_f32_16x16x32_bf16 v[140:143], v[180:183], v[36:39], v[140:143]
    v_mul_f32_e64 v87, -s70, v87
    v_add_f32 v86, 1.0, v86
    v_exp_f32 v87, v87
    ds_read_b128 v[52:55], v6 offset:26624
    s_waitcnt lgkmcnt(7)
    v_mfma_f32_16x16x32_bf16 v[128:131], v[184:187], v[40:43], v[128:131]
    v_mul_f32 v93, v93, v85
    v_rcp_f32 v86, v86
    v_mfma_f32_16x16x32_bf16 v[136:139], v[188:191], v[40:43], v[136:139]
    v_cvt_pk_bf16_f32 v4, v92, v93
    v_add_f32 v87, 1.0, v87
    v_mul_f32 v94, v94, v86
    ds_read_b128 v[56:59], v7 offset:24576
    s_add_u32 m0, s4, 5120
    s_add_u32 s74, s5, 78848
    buffer_load_dwordx4 v10, s[44:47], s74 offen lds
    s_waitcnt lgkmcnt(7)
    v_mfma_f32_16x16x32_bf16 v[132:135], v[184:187], v[44:47], v[132:135]
    v_rcp_f32 v87, v87
    s_nop 0
    v_mul_f32 v95, v95, v87
    v_mfma_f32_16x16x32_bf16 v[140:143], v[188:191], v[44:47], v[140:143]
    v_cvt_pk_bf16_f32 v5, v94, v95
    v_permlane16_swap_b32 v2, v4
    s_nop 0
    v_permlane16_swap_b32 v3, v5
    ds_read_b128 v[60:63], v7 offset:26624
    s_waitcnt lgkmcnt(3)
    v_mfma_f32_16x16x32_bf16 v[128:131], v[192:195], v[48:51], v[128:131]
    v_mul_f32 v72, v64, v72
    v_mul_f32_e64 v64, -s70, v64
    v_exp_f32 v64, v64
    v_mfma_f32_16x16x32_bf16 v[136:139], v[196:199], v[48:51], v[136:139]
    v_mul_f32 v73, v65, v73
    v_mul_f32_e64 v65, -s70, v65
    ds_read_b128 v[32:35], v6 offset:32768
    s_add_u32 m0, s4, 49152
    s_add_u32 s74, s5, 86016
    buffer_load_dwordx4 v10, s[44:47], s74 offen lds
    s_waitcnt lgkmcnt(3)
    v_mfma_f32_16x16x32_bf16 v[132:135], v[192:195], v[52:55], v[132:135]
    v_add_f32 v64, 1.0, v64
    v_exp_f32 v65, v65
    v_mfma_f32_16x16x32_bf16 v[140:143], v[196:199], v[52:55], v[140:143]
    v_rcp_f32 v64, v64
    v_mul_f32 v74, v66, v74
    v_mul_f32_e64 v66, -s70, v66
    ds_read_b128 v[36:39], v6 offset:34816
    s_waitcnt vmcnt(9)
    ds_read_b64_tr_b16 v[80:81], v11 offset:51200
    ds_read_b64_tr_b16 v[82:83], v11 offset:52224
    ds_read_b64_tr_b16 v[84:85], v12 offset:51200
    ds_read_b64_tr_b16 v[86:87], v12 offset:52224
    s_waitcnt lgkmcnt(7)
    v_mfma_f32_16x16x32_bf16 v[128:131], v[200:203], v[56:59], v[128:131]
    v_add_f32 v65, 1.0, v65
    v_exp_f32 v66, v66
    v_mfma_f32_16x16x32_bf16 v[136:139], v[204:207], v[56:59], v[136:139]
    v_mul_f32 v72, v72, v64
    v_rcp_f32 v65, v65
    ds_read_b128 v[40:43], v7 offset:32768
    s_add_u32 m0, s4, 50176
    s_add_u32 s74, s5, 93184
    buffer_load_dwordx4 v10, s[44:47], s74 offen lds
    s_waitcnt lgkmcnt(7)
    v_mfma_f32_16x16x32_bf16 v[132:135], v[200:203], v[60:63], v[132:135]
    v_mul_f32 v75, v67, v75
    v_mul_f32_e64 v67, -s70, v67
    v_add_f32 v66, 1.0, v66
    v_mfma_f32_16x16x32_bf16 v[140:143], v[204:207], v[60:63], v[140:143]
    v_exp_f32 v67, v67
    v_mul_f32 v73, v73, v65
    ds_read_b128 v[44:47], v7 offset:34816
    s_waitcnt vmcnt(8)
    ds_read_b64_tr_b16 v[88:89], v11 offset:53248
    ds_read_b64_tr_b16 v[90:91], v11 offset:54272
    ds_read_b64_tr_b16 v[92:93], v12 offset:53248
    ds_read_b64_tr_b16 v[94:95], v12 offset:54272
    s_waitcnt lgkmcnt(11)
    v_mfma_f32_16x16x32_bf16 v[128:131], v[208:211], v[32:35], v[128:131]
    v_rcp_f32 v66, v66
    v_cvt_pk_bf16_f32 v28, v72, v73
    v_mul_f32 v76, v68, v76
    v_mfma_f32_16x16x32_bf16 v[136:139], v[212:215], v[32:35], v[136:139]
    v_mul_f32_e64 v68, -s70, v68
    v_add_f32 v67, 1.0, v67
    ds_read_b128 v[48:51], v6 offset:40960
    s_waitcnt lgkmcnt(7)
    s_add_u32 m0, s4, 51200
    s_add_u32 s74, s5, 100352
    buffer_load_dwordx4 v10, s[44:47], s74 offen lds
    v_mfma_f32_16x16x32_bf16 v[132:135], v[208:211], v[36:39], v[132:135]
    v_exp_f32 v68, v68
    v_mul_f32 v74, v74, v66
    v_mfma_f32_16x16x32_bf16 v[140:143], v[212:215], v[36:39], v[140:143]
    v_rcp_f32 v67, v67
    v_mul_f32 v77, v69, v77
    v_mul_f32_e64 v69, -s70, v69
    ds_read_b128 v[52:55], v6 offset:43008
    s_waitcnt lgkmcnt(7)
    v_mfma_f32_16x16x32_bf16 v[128:131], v[216:219], v[40:43], v[128:131]
    v_add_f32 v68, 1.0, v68
    v_exp_f32 v69, v69
    v_mfma_f32_16x16x32_bf16 v[136:139], v[220:223], v[40:43], v[136:139]
    v_mul_f32 v75, v75, v67
    v_rcp_f32 v68, v68
    v_cvt_pk_bf16_f32 v29, v74, v75
    ds_read_b128 v[56:59], v7 offset:40960
    s_add_u32 m0, s4, 52224
    s_add_u32 s74, s5, 107520
    buffer_load_dwordx4 v10, s[44:47], s74 offen lds
    s_waitcnt lgkmcnt(7)
    v_mfma_f32_16x16x32_bf16 v[132:135], v[216:219], v[44:47], v[132:135]
    v_mul_f32 v78, v70, v78
    v_mul_f32_e64 v70, -s70, v70
    v_add_f32 v69, 1.0, v69
    v_mfma_f32_16x16x32_bf16 v[140:143], v[220:223], v[44:47], v[140:143]
    v_exp_f32 v70, v70
    v_mul_f32 v76, v76, v68
    ds_read_b128 v[60:63], v7 offset:43008
    s_waitcnt lgkmcnt(4)
    s_add_u32 m0, s4, 53248
    s_add_u32 s74, s5, 114688
    buffer_load_dwordx4 v10, s[44:47], s74 offen lds
    s_waitcnt lgkmcnt(3)
    v_mfma_f32_16x16x32_bf16 v[128:131], v[224:227], v[48:51], v[128:131]
    v_rcp_f32 v69, v69
    v_mul_f32 v79, v71, v79
    v_mfma_f32_16x16x32_bf16 v[136:139], v[228:231], v[48:51], v[136:139]
    v_mul_f32_e64 v71, -s70, v71
    v_add_f32 v70, 1.0, v70
    v_exp_f32 v71, v71
    ds_read_b128 v[32:35], v6 offset:49152
    s_waitcnt lgkmcnt(3)
    v_mfma_f32_16x16x32_bf16 v[132:135], v[224:227], v[52:55], v[132:135]
    v_mul_f32 v77, v77, v69
    v_rcp_f32 v70, v70
    v_mfma_f32_16x16x32_bf16 v[140:143], v[228:231], v[52:55], v[140:143]
    v_cvt_pk_bf16_f32 v30, v76, v77
    v_add_f32 v71, 1.0, v71
    v_mul_f32 v78, v78, v70
    ds_read_b128 v[36:39], v6 offset:51200
    s_add_u32 m0, s4, 54272
    s_add_u32 s74, s5, 121856
    buffer_load_dwordx4 v10, s[44:47], s74 offen lds
    s_waitcnt lgkmcnt(3)
    v_mfma_f32_16x16x32_bf16 v[128:131], v[232:235], v[56:59], v[128:131]
    v_rcp_f32 v71, v71
    s_nop 0
    v_mul_f32 v79, v79, v71
    v_mfma_f32_16x16x32_bf16 v[136:139], v[236:239], v[56:59], v[136:139]
    v_cvt_pk_bf16_f32 v31, v78, v79
    v_permlane16_swap_b32 v28, v30
    s_nop 0
    v_permlane16_swap_b32 v29, v31
    ds_read_b128 v[40:43], v7 offset:49152
    s_waitcnt lgkmcnt(3)
    v_mfma_f32_16x16x32_bf16 v[132:135], v[232:235], v[60:63], v[132:135]
    s_add_u32 s74, s71, 0
    buffer_store_dwordx4 v[28:31], v1, s[40:43], s74 offen sc1
    s_add_u32 s74, s71, 114688
    buffer_store_dwordx4 v[2:5], v1, s[40:43], s74 offen sc1
    v_mul_f32 v104, v96, v104
    v_mul_f32_e64 v96, -s70, v96
    v_exp_f32 v96, v96
    v_mfma_f32_16x16x32_bf16 v[140:143], v[236:239], v[60:63], v[140:143]
    v_mul_f32 v105, v97, v105
    v_mul_f32_e64 v97, -s70, v97
    ds_read_b128 v[44:47], v7 offset:51200
    s_waitcnt lgkmcnt(3)
    v_mfma_f32_16x16x32_bf16 v[128:131], v[240:243], v[32:35], v[128:131]
    v_add_f32 v96, 1.0, v96
    v_exp_f32 v97, v97
    v_mfma_f32_16x16x32_bf16 v[136:139], v[244:247], v[32:35], v[136:139]
    v_rcp_f32 v96, v96
    v_mul_f32 v106, v98, v106
    v_mul_f32_e64 v98, -s70, v98
    ds_read_b128 v[48:51], v6 offset:4096
    s_waitcnt lgkmcnt(3)
    v_mfma_f32_16x16x32_bf16 v[132:135], v[240:243], v[36:39], v[132:135]
    v_add_f32 v97, 1.0, v97
    v_exp_f32 v98, v98
    v_mfma_f32_16x16x32_bf16 v[140:143], v[244:247], v[36:39], v[140:143]
    v_mul_f32 v104, v104, v96
    v_rcp_f32 v97, v97
    ds_read_b128 v[52:55], v6 offset:6144
    s_waitcnt lgkmcnt(2)
    s_barrier
    v_mfma_f32_16x16x32_bf16 v[128:131], v[248:251], v[40:43], v[128:131]
    v_mul_f32 v107, v99, v107
    v_mul_f32_e64 v99, -s70, v99
    v_add_f32 v98, 1.0, v98
    v_mfma_f32_16x16x32_bf16 v[136:139], v[252:255], v[40:43], v[136:139]
    v_exp_f32 v99, v99
    v_mul_f32 v105, v105, v97
    ds_read_b128 v[56:59], v7 offset:4096
    s_add_u32 m0, s27, 98304
    s_add_u32 s74, s10, 0
    buffer_load_dwordx4 v10, s[48:51], s74 offen lds
    s_add_u32 m0, s27, 99328
    s_add_u32 s74, s10, 7168
    buffer_load_dwordx4 v10, s[48:51], s74 offen lds
    v_mfma_f32_16x16x32_bf16 v[132:135], v[248:251], v[44:47], v[132:135]
    v_rcp_f32 v98, v98
    v_cvt_pk_bf16_f32 v96, v104, v105
    v_mul_f32 v108, v100, v108
    v_mfma_f32_16x16x32_bf16 v[140:143], v[252:255], v[44:47], v[140:143]
    v_mul_f32_e64 v100, -s70, v100
    v_add_f32 v99, 1.0, v99
    ds_read_b128 v[60:63], v7 offset:6144
    s_waitcnt lgkmcnt(3)
    v_mfma_f32_16x16x32_bf16 v[64:67], v[144:147], v[48:51], 0
    v_exp_f32 v100, v100
    v_mul_f32 v106, v106, v98
    v_mfma_f32_16x16x32_bf16 v[72:75], v[148:151], v[48:51], 0
    v_rcp_f32 v99, v99
    v_mul_f32 v109, v101, v109
    v_mul_f32_e64 v101, -s70, v101
    ds_read_b128 v[32:35], v6 offset:12288
    s_add_u32 m0, s27, 100352
    s_add_u32 s74, s10, 14336
    buffer_load_dwordx4 v10, s[48:51], s74 offen lds
    s_add_u32 m0, s27, 101376
    s_add_u32 s74, s10, 21504
    buffer_load_dwordx4 v15, s[48:51], s74 offen lds
    s_waitcnt lgkmcnt(3)
    v_mfma_f32_16x16x32_bf16 v[68:71], v[144:147], v[52:55], 0
    v_add_f32 v100, 1.0, v100
    v_exp_f32 v101, v101
    v_mfma_f32_16x16x32_bf16 v[76:79], v[148:151], v[52:55], 0
    v_mul_f32 v107, v107, v99
    v_rcp_f32 v100, v100
    v_cvt_pk_bf16_f32 v97, v106, v107
    ds_read_b128 v[36:39], v6 offset:14336
    s_waitcnt lgkmcnt(3)
    v_mfma_f32_16x16x32_bf16 v[64:67], v[152:155], v[56:59], v[64:67]
    v_mul_f32 v110, v102, v110
    v_mul_f32_e64 v102, -s70, v102
    v_add_f32 v101, 1.0, v101
    v_mfma_f32_16x16x32_bf16 v[72:75], v[156:159], v[56:59], v[72:75]
    v_exp_f32 v102, v102
    v_mul_f32 v108, v108, v100
    ds_read_b128 v[40:43], v7 offset:12288
    s_waitcnt vmcnt(16)
    ds_read_b64_tr_b16 v[144:145], v11 offset:0
    ds_read_b64_tr_b16 v[146:147], v11 offset:1024
    ds_read_b64_tr_b16 v[148:149], v12 offset:0
    ds_read_b64_tr_b16 v[150:151], v12 offset:1024
    s_waitcnt lgkmcnt(7)
    v_mfma_f32_16x16x32_bf16 v[68:71], v[152:155], v[60:63], v[68:71]
    v_rcp_f32 v101, v101
    v_mul_f32 v111, v103, v111
    v_mfma_f32_16x16x32_bf16 v[76:79], v[156:159], v[60:63], v[76:79]
    v_mul_f32_e64 v103, -s70, v103
    v_add_f32 v102, 1.0, v102
    v_exp_f32 v103, v103
    ds_read_b128 v[44:47], v7 offset:14336
    s_waitcnt lgkmcnt(1)
    s_add_u32 m0, s4, 0
    s_add_u32 s74, s5, 129024
    buffer_load_dwordx4 v10, s[44:47], s74 offen lds
    v_mfma_f32_16x16x32_bf16 v[64:67], v[160:163], v[32:35], v[64:67]
    v_mul_f32 v109, v109, v101
    v_rcp_f32 v102, v102
    v_mfma_f32_16x16x32_bf16 v[72:75], v[164:167], v[32:35], v[72:75]
    v_cvt_pk_bf16_f32 v98, v108, v109
    v_add_f32 v103, 1.0, v103
    v_mul_f32 v110, v110, v102
    ds_read_b128 v[48:51], v6 offset:20480
    s_waitcnt vmcnt(15)
    ds_read_b64_tr_b16 v[152:153], v11 offset:2048
    ds_read_b64_tr_b16 v[154:155], v11 offset:3072
    ds_read_b64_tr_b16 v[156:157], v12 offset:2048
    ds_read_b64_tr_b16 v[158:159], v12 offset:3072
    v_mfma_f32_16x16x32_bf16 v[68:71], v[160:163], v[36:39], v[68:71]
    v_rcp_f32 v103, v103
    s_nop 0
    v_mul_f32 v111, v111, v103
    v_mfma_f32_16x16x32_bf16 v[76:79], v[164:167], v[36:39], v[76:79]
    v_cvt_pk_bf16_f32 v99, v110, v111
    v_permlane16_swap_b32 v96, v98
    s_nop 0
    v_permlane16_swap_b32 v97, v99
    ds_read_b128 v[52:55], v6 offset:22528
    s_add_u32 m0, s4, 1024
    s_add_u32 s74, s5, 136192
    buffer_load_dwordx4 v10, s[44:47], s74 offen lds
    v_mfma_f32_16x16x32_bf16 v[64:67], v[168:171], v[40:43], v[64:67]
    v_mul_f32 v120, v112, v120
    v_mul_f32_e64 v112, -s70, v112
    v_exp_f32 v112, v112
    v_mfma_f32_16x16x32_bf16 v[72:75], v[172:175], v[40:43], v[72:75]
    v_mul_f32 v121, v113, v121
    v_mul_f32_e64 v113, -s70, v113
    ds_read_b128 v[56:59], v7 offset:20480
    s_waitcnt vmcnt(14)
    ds_read_b64_tr_b16 v[160:161], v11 offset:4096
    ds_read_b64_tr_b16 v[162:163], v11 offset:5120
    ds_read_b64_tr_b16 v[164:165], v12 offset:4096
    ds_read_b64_tr_b16 v[166:167], v12 offset:5120
    s_waitcnt lgkmcnt(6)
    s_add_u32 m0, s4, 2048
    s_add_u32 s74, s5, 143360
    buffer_load_dwordx4 v10, s[44:47], s74 offen lds
    v_mfma_f32_16x16x32_bf16 v[68:71], v[168:171], v[44:47], v[68:71]
    v_add_f32 v112, 1.0, v112
    v_exp_f32 v113, v113
    v_mfma_f32_16x16x32_bf16 v[76:79], v[172:175], v[44:47], v[76:79]
    v_rcp_f32 v112, v112
    v_mul_f32 v122, v114, v122
    v_mul_f32_e64 v114, -s70, v114
    ds_read_b128 v[60:63], v7 offset:22528
    v_mfma_f32_16x16x32_bf16 v[64:67], v[176:179], v[48:51], v[64:67]
    v_add_f32 v113, 1.0, v113
    v_exp_f32 v114, v114
    v_mfma_f32_16x16x32_bf16 v[72:75], v[180:183], v[48:51], v[72:75]
    v_mul_f32 v120, v120, v112
    v_rcp_f32 v113, v113
    ds_read_b128 v[32:35], v6 offset:28672
    s_waitcnt vmcnt(13)
    ds_read_b64_tr_b16 v[168:169], v11 offset:49152
    ds_read_b64_tr_b16 v[170:171], v11 offset:50176
    ds_read_b64_tr_b16 v[172:173], v12 offset:49152
    ds_read_b64_tr_b16 v[174:175], v12 offset:50176
    s_add_u32 m0, s4, 3072
    s_add_u32 s74, s5, 150528
    buffer_load_dwordx4 v10, s[44:47], s74 offen lds
    s_waitcnt lgkmcnt(11)
    v_mfma_f32_16x16x32_bf16 v[68:71], v[176:179], v[52:55], v[68:71]
    v_mul_f32 v123, v115, v123
    v_mul_f32_e64 v115, -s70, v115
    v_add_f32 v114, 1.0, v114
    v_mfma_f32_16x16x32_bf16 v[76:79], v[180:183], v[52:55], v[76:79]
    v_exp_f32 v115, v115
    v_mul_f32 v121, v121, v113
    ds_read_b128 v[36:39], v6 offset:30720
    s_waitcnt lgkmcnt(7)
    s_add_u32 m0, s4, 4096
    s_add_u32 s74, s5, 157696
    buffer_load_dwordx4 v10, s[44:47], s74 offen lds
    v_mfma_f32_16x16x32_bf16 v[64:67], v[184:187], v[56:59], v[64:67]
    v_rcp_f32 v114, v114
    v_cvt_pk_bf16_f32 v112, v120, v121
    v_mul_f32 v124, v116, v124
    v_mfma_f32_16x16x32_bf16 v[72:75], v[188:191], v[56:59], v[72:75]
    v_mul_f32_e64 v116, -s70, v116
    v_add_f32 v115, 1.0, v115
    ds_read_b128 v[40:43], v7 offset:28672
    s_waitcnt vmcnt(13)
    ds_read_b64_tr_b16 v[176:177], v11 offset:51200
    ds_read_b64_tr_b16 v[178:179], v11 offset:52224
    ds_read_b64_tr_b16 v[180:181], v12 offset:51200
    ds_read_b64_tr_b16 v[182:183], v12 offset:52224
    s_waitcnt lgkmcnt(11)
    v_mfma_f32_16x16x32_bf16 v[68:71], v[184:187], v[60:63], v[68:71]
    v_exp_f32 v116, v116
    v_mul_f32 v122, v122, v114
    v_mfma_f32_16x16x32_bf16 v[76:79], v[188:191], v[60:63], v[76:79]
    v_rcp_f32 v115, v115
    v_mul_f32 v125, v117, v125
    v_mul_f32_e64 v117, -s70, v117
    ds_read_b128 v[44:47], v7 offset:30720
    s_add_u32 m0, s4, 5120
    s_add_u32 s74, s5, 164864
    buffer_load_dwordx4 v10, s[44:47], s74 offen lds
    s_waitcnt lgkmcnt(11)
    v_mfma_f32_16x16x32_bf16 v[64:67], v[192:195], v[32:35], v[64:67]
    v_add_f32 v116, 1.0, v116
    v_exp_f32 v117, v117
    v_mfma_f32_16x16x32_bf16 v[72:75], v[196:199], v[32:35], v[72:75]
    v_mul_f32 v123, v123, v115
    v_rcp_f32 v116, v116
    v_cvt_pk_bf16_f32 v113, v122, v123
    ds_read_b128 v[48:51], v6 offset:36864
    s_waitcnt lgkmcnt(2)
    s_add_u32 m0, s4, 49152
    s_add_u32 s74, s10, 25088
    buffer_load_dwordx4 v10, s[48:51], s74 offen lds
    s_add_u32 m0, s4, 50176
    s_add_u32 s74, s10, 32256
    buffer_load_dwordx4 v10, s[48:51], s74 offen lds
    v_mfma_f32_16x16x32_bf16 v[68:71], v[192:195], v[36:39], v[68:71]
    v_mul_f32 v126, v118, v126
    v_mul_f32_e64 v118, -s70, v118
    v_add_f32 v117, 1.0, v117
    v_mfma_f32_16x16x32_bf16 v[76:79], v[196:199], v[36:39], v[76:79]
    v_exp_f32 v118, v118
    v_mul_f32 v124, v124, v116
    ds_read_b128 v[52:55], v6 offset:38912
    v_mfma_f32_16x16x32_bf16 v[64:67], v[200:203], v[40:43], v[64:67]
    v_rcp_f32 v117, v117
    v_mul_f32 v127, v119, v127
    v_mfma_f32_16x16x32_bf16 v[72:75], v[204:207], v[40:43], v[72:75]
    v_mul_f32_e64 v119, -s70, v119
    v_add_f32 v118, 1.0, v118
    v_exp_f32 v119, v119
    ds_read_b128 v[56:59], v7 offset:36864
    s_waitcnt vmcnt(14)
    ds_read_b64_tr_b16 v[184:185], v11 offset:53248
    ds_read_b64_tr_b16 v[186:187], v11 offset:54272
    ds_read_b64_tr_b16 v[188:189], v12 offset:53248
    ds_read_b64_tr_b16 v[190:191], v12 offset:54272
    s_add_u32 m0, s4, 51200
    s_add_u32 s74, s10, 39424
    buffer_load_dwordx4 v10, s[48:51], s74 offen lds
    s_add_u32 m0, s4, 52224
    s_add_u32 s74, s10, 46592
    buffer_load_dwordx4 v15, s[48:51], s74 offen lds
    s_waitcnt lgkmcnt(7)
    v_mfma_f32_16x16x32_bf16 v[68:71], v[200:203], v[44:47], v[68:71]
    v_mul_f32 v125, v125, v117
    v_rcp_f32 v118, v118
    v_mfma_f32_16x16x32_bf16 v[76:79], v[204:207], v[44:47], v[76:79]
    v_cvt_pk_bf16_f32 v114, v124, v125
    v_add_f32 v119, 1.0, v119
    v_mul_f32 v126, v126, v118
    ds_read_b128 v[60:63], v7 offset:38912
    s_waitcnt lgkmcnt(7)
    v_mfma_f32_16x16x32_bf16 v[64:67], v[208:211], v[48:51], v[64:67]
    v_rcp_f32 v119, v119
    s_nop 0
    v_mul_f32 v127, v127, v119
    v_mfma_f32_16x16x32_bf16 v[72:75], v[212:215], v[48:51], v[72:75]
    v_cvt_pk_bf16_f32 v115, v126, v127
    v_permlane16_swap_b32 v112, v114
    s_nop 0
    v_permlane16_swap_b32 v113, v115
    ds_read_b128 v[32:35], v6 offset:45056
    s_waitcnt lgkmcnt(7)
    v_mfma_f32_16x16x32_bf16 v[68:71], v[208:211], v[52:55], v[68:71]
    s_waitcnt vmcnt(14)
    s_barrier
    s_cmp_eq_u32 s60, 7
    s_cbranch_scc0 L_no2
    s_add_u32 s74, s3, 0
    buffer_store_dword v18, v17, s[40:43], s74 offen sc1
L_no2:
    s_add_u32 s74, s71, 229376
    buffer_store_dwordx4 v[96:99], v1, s[40:43], s74 offen sc1
    s_add_u32 s74, s71, 344064
    buffer_store_dwordx4 v[112:115], v1, s[40:43], s74 offen sc1
    v_mul_f32 v136, v128, v136
    v_mul_f32_e64 v128, -s70, v128
    v_exp_f32 v128, v128
    v_mfma_f32_16x16x32_bf16 v[76:79], v[212:215], v[52:55], v[76:79]
    v_mul_f32 v137, v129, v137
    v_mul_f32_e64 v129, -s70, v129
    ds_read_b128 v[36:39], v6 offset:47104
    s_waitcnt lgkmcnt(7)
    v_mfma_f32_16x16x32_bf16 v[64:67], v[216:219], v[56:59], v[64:67]
    v_add_f32 v128, 1.0, v128
    v_exp_f32 v129, v129
    v_mfma_f32_16x16x32_bf16 v[72:75], v[220:223], v[56:59], v[72:75]
    v_rcp_f32 v128, v128
    v_mul_f32 v138, v130, v138
    v_mul_f32_e64 v130, -s70, v130
    ds_read_b128 v[40:43], v7 offset:45056
    s_waitcnt lgkmcnt(3)
    v_mfma_f32_16x16x32_bf16 v[68:71], v[216:219], v[60:63], v[68:71]
    v_add_f32 v129, 1.0, v129
    v_exp_f32 v130, v130
    v_mfma_f32_16x16x32_bf16 v[76:79], v[220:223], v[60:63], v[76:79]
    v_mul_f32 v136, v136, v128
    v_rcp_f32 v129, v129
    ds_read_b128 v[44:47], v7 offset:47104
    s_add_u32 m0, s4, 53248
    s_add_u32 s74, s5, 172032
    buffer_load_dwordx4 v10, s[44:47], s74 offen lds
    s_waitcnt lgkmcnt(3)
    v_mfma_f32_16x16x32_bf16 v[64:67], v[224:227], v[32:35], v[64:67]
    v_mul_f32 v139, v131, v139
    v_mul_f32_e64 v131, -s70, v131
    v_add_f32 v130, 1.0, v130
    v_mfma_f32_16x16x32_bf16 v[72:75], v[228:231], v[32:35], v[72:75]
    v_exp_f32 v131, v131
    v_mul_f32 v137, v137, v129
    ds_read_b128 v[48:51], v6 offset:53248
    s_waitcnt lgkmcnt(3)
    v_mfma_f32_16x16x32_bf16 v[68:71], v[224:227], v[36:39], v[68:71]
    v_rcp_f32 v130, v130
    v_cvt_pk_bf16_f32 v128, v136, v137
    v_mul_f32 v140, v132, v140
    v_mfma_f32_16x16x32_bf16 v[76:79], v[228:231], v[36:39], v[76:79]
    v_mul_f32_e64 v132, -s70, v132
    v_add_f32 v131, 1.0, v131
    ds_read_b128 v[52:55], v6 offset:55296
    s_waitcnt vmcnt(11)
    ds_read_b64_tr_b16 v[192:193], v11 offset:0
    ds_read_b64_tr_b16 v[194:195], v11 offset:1024
    ds_read_b64_tr_b16 v[196:197], v12 offset:0
    ds_read_b64_tr_b16 v[198:199], v12 offset:1024
    s_add_u32 m0, s4, 54272
    s_add_u32 s74, s5, 179200
    buffer_load_dwordx4 v10, s[44:47], s74 offen lds
    s_waitcnt lgkmcnt(7)
    v_mfma_f32_16x16x32_bf16 v[64:67], v[232:235], v[40:43], v[64:67]
    v_exp_f32 v132, v132
    v_mul_f32 v138, v138, v130
    v_mfma_f32_16x16x32_bf16 v[72:75], v[236:239], v[40:43], v[72:75]
    v_rcp_f32 v131, v131
    v_mul_f32 v141, v133, v141
    v_mul_f32_e64 v133, -s70, v133
    ds_read_b128 v[56:59], v7 offset:53248
    s_waitcnt lgkmcnt(7)
    v_mfma_f32_16x16x32_bf16 v[68:71], v[232:235], v[44:47], v[68:71]
    v_add_f32 v132, 1.0, v132
    v_exp_f32 v133, v133
    v_mfma_f32_16x16x32_bf16 v[76:79], v[236:239], v[44:47], v[76:79]
    v_mul_f32 v139, v139, v131
    v_rcp_f32 v132, v132
    v_cvt_pk_bf16_f32 v129, v138, v139
    ds_read_b128 v[60:63], v7 offset:55296
    s_waitcnt lgkmcnt(2)
    s_add_u32 m0, s4, 0
    s_add_u32 s74, s5, 186368
    buffer_load_dwordx4 v10, s[44:47], s74 offen lds
    v_mfma_f32_16x16x32_bf16 v[64:67], v[240:243], v[48:51], v[64:67]
    v_mul_f32 v142, v134, v142
    v_mul_f32_e64 v134, -s70, v134
    v_add_f32 v133, 1.0, v133
    v_mfma_f32_16x16x32_bf16 v[72:75], v[244:247], v[48:51], v[72:75]
    v_exp_f32 v134, v134
    v_mul_f32 v140, v140, v132
    v_mfma_f32_16x16x32_bf16 v[68:71], v[240:243], v[52:55], v[68:71]
    v_rcp_f32 v133, v133
    v_mul_f32 v143, v135, v143
    v_mfma_f32_16x16x32_bf16 v[76:79], v[244:247], v[52:55], v[76:79]
    v_mul_f32_e64 v135, -s70, v135
    v_add_f32 v134, 1.0, v134
    v_exp_f32 v135, v135
    s_add_u32 m0, s4, 1024
    s_add_u32 s74, s5, 193536
    buffer_load_dwordx4 v10, s[44:47], s74 offen lds
    s_waitcnt lgkmcnt(1)
    v_mfma_f32_16x16x32_bf16 v[64:67], v[248:251], v[56:59], v[64:67]
    v_mul_f32 v141, v141, v133
    v_rcp_f32 v134, v134
    v_mfma_f32_16x16x32_bf16 v[72:75], v[252:255], v[56:59], v[72:75]
    v_cvt_pk_bf16_f32 v130, v140, v141
    v_add_f32 v135, 1.0, v135
    v_mul_f32 v142, v142, v134
    s_waitcnt lgkmcnt(0)
    v_mfma_f32_16x16x32_bf16 v[68:71], v[248:251], v[60:63], v[68:71]
    v_rcp_f32 v135, v135
    s_nop 0
    v_mul_f32 v143, v143, v135
    v_mfma_f32_16x16x32_bf16 v[76:79], v[252:255], v[60:63], v[76:79]
    v_cvt_pk_bf16_f32 v131, v142, v143
    v_permlane16_swap_b32 v128, v130
    s_nop 0
    v_permlane16_swap_b32 v129, v131
    s_waitcnt vmcnt(12)
    ds_read_b64_tr_b16 v[96:97], v11 offset:2048
    ds_read_b64_tr_b16 v[98:99], v11 offset:3072
    ds_read_b64_tr_b16 v[100:101], v12 offset:2048
    ds_read_b64_tr_b16 v[102:103], v12 offset:3072
    s_waitcnt vmcnt(10)
    ds_read_b64_tr_b16 v[104:105], v11 offset:4096
    ds_read_b64_tr_b16 v[106:107], v11 offset:5120
    ds_read_b64_tr_b16 v[108:109], v12 offset:4096
    ds_read_b64_tr_b16 v[110:111], v12 offset:5120
    v_pk_mul_f32 v[72:73], v[64:65], v[72:73]
    v_pk_mul_f32 v[74:75], v[66:67], v[74:75]
    v_pk_mul_f32 v[76:77], v[68:69], v[76:77]
    v_pk_mul_f32 v[78:79], v[70:71], v[78:79]
    v_pk_mul_f32 v[64:65], v[64:65], s[70:71] op_sel_hi:[1,0] neg_lo:[1,0] neg_hi:[1,0]
    v_pk_mul_f32 v[66:67], v[66:67], s[70:71] op_sel_hi:[1,0] neg_lo:[1,0] neg_hi:[1,0]
    v_pk_mul_f32 v[68:69], v[68:69], s[70:71] op_sel_hi:[1,0] neg_lo:[1,0] neg_hi:[1,0]
    v_pk_mul_f32 v[70:71], v[70:71], s[70:71] op_sel_hi:[1,0] neg_lo:[1,0] neg_hi:[1,0]
    v_exp_f32 v64, v64
    v_exp_f32 v65, v65
    v_exp_f32 v66, v66
    v_exp_f32 v67, v67
    v_exp_f32 v68, v68
    buffer_load_dword v16, v13, s[40:43], s11 offen sc1
    v_exp_f32 v69, v69
    v_exp_f32 v70, v70
    v_exp_f32 v71, v71
    v_pk_add_f32 v[64:65], v[64:65], 1.0 op_sel_hi:[1,0]
    v_pk_add_f32 v[66:67], v[66:67], 1.0 op_sel_hi:[1,0]
    v_pk_add_f32 v[68:69], v[68:69], 1.0 op_sel_hi:[1,0]
    v_pk_add_f32 v[70:71], v[70:71], 1.0 op_sel_hi:[1,0]
    v_rcp_f32 v64, v64
    v_rcp_f32 v65, v65
    v_rcp_f32 v66, v66
    v_rcp_f32 v67, v67
    v_rcp_f32 v68, v68
    v_rcp_f32 v69, v69
    v_rcp_f32 v70, v70
    v_rcp_f32 v71, v71
    v_pk_mul_f32 v[72:73], v[72:73], v[64:65]
    v_pk_mul_f32 v[74:75], v[74:75], v[66:67]
    v_pk_mul_f32 v[76:77], v[76:77], v[68:69]
    v_pk_mul_f32 v[78:79], v[78:79], v[70:71]
    v_cvt_pk_bf16_f32 v64, v72, v73
    v_cvt_pk_bf16_f32 v65, v74, v75
    v_cvt_pk_bf16_f32 v66, v76, v77
    v_cvt_pk_bf16_f32 v67, v78, v79
    s_nop 0
    v_permlane16_swap_b32 v64, v66
    v_permlane16_swap_b32 v65, v67
    s_waitcnt vmcnt(5)
    s_barrier
    s_cmp_eq_u32 s60, 7
    s_cbranch_scc0 L_no3
    s_add_u32 s74, s3, 3584
    buffer_store_dword v18, v17, s[40:43], s74 offen sc1
L_no3:
    s_add_u32 s74, s71, 458752
    buffer_store_dwordx4 v[128:131], v1, s[40:43], s74 offen sc1
    s_add_u32 s74, s71, 573440
    buffer_store_dwordx4 v[64:67], v1, s[40:43], s74 offen sc1
    s_waitcnt vmcnt(2)
    v_cmp_eq_u32 vcc, 0, v16
    s_nop 1
    s_and_b32 s74, vcc_lo, 7
    s_cbranch_scc1 L_e_late
    buffer_load_dwordx4 v[200:203], v1, s[40:43], s83 offen offset:0 sc1
    buffer_load_dwordx4 v[204:207], v1, s[40:43], s83 offen offset:1024 sc1
    buffer_load_dwordx4 v[208:211], v1, s[40:43], s83 offen offset:2048 sc1
    buffer_load_dwordx4 v[212:215], v1, s[40:43], s83 offen offset:3072 sc1
    s_add_u32 s83, s83, 4096
    buffer_load_dwordx4 v[216:219], v1, s[40:43], s83 offen offset:0 sc1
    buffer_load_dwordx4 v[220:223], v1, s[40:43], s83 offen offset:1024 sc1
    s_waitcnt vmcnt(6)
    s_barrier
    s_cmp_eq_u32 s60, 7
    s_cbranch_scc0 L_no4
    s_add_u32 s74, s3, 7168
    buffer_store_dword v18, v17, s[40:43], s74 offen sc1
L_no4:
    s_waitcnt lgkmcnt(0)
    s_branch L_join2
L_e_late:
    s_waitcnt lgkmcnt(0)
    s_waitcnt vmcnt(0)
    s_barrier
    s_cmp_eq_u32 s60, 7
    s_cbranch_scc0 L_no5
    s_add_u32 s74, s3, 7168
    buffer_store_dword v18, v17, s[40:43], s74 offen sc1
L_no5:
    buffer_load_dword v16, v13, s[40:43], s11 offen sc1
    s_waitcnt vmcnt(0)
    s_branch L_join
L_ffn_short:
    s_waitcnt lgkmcnt(0)
    s_nop 7
    s_add_u32 m0, s4, 0
    s_add_u32 s74, s5, 43008
    buffer_load_dwordx4 v10, s[44:47], s74 offen lds
    s_add_u32 m0, s4, 1024
    s_add_u32 s74, s5, 50176
    buffer_load_dwordx4 v10, s[44:47], s74 offen lds
    v_pk_mul_f32 v[72:73], v[64:65], v[72:73]
    v_pk_mul_f32 v[74:75], v[66:67], v[74:75]
    v_pk_mul_f32 v[76:77], v[68:69], v[76:77]
    v_pk_mul_f32 v[78:79], v[70:71], v[78:79]
    v_pk_mul_f32 v[64:65], v[64:65], s[70:71] op_sel_hi:[1,0] neg_lo:[1,0] neg_hi:[1,0]
    v_pk_mul_f32 v[66:67], v[66:67], s[70:71] op_sel_hi:[1,0] neg_lo:[1,0] neg_hi:[1,0]
    v_pk_mul_f32 v[68:69], v[68:69], s[70:71] op_sel_hi:[1,0] neg_lo:[1,0] neg_hi:[1,0]
    v_pk_mul_f32 v[70:71], v[70:71], s[70:71] op_sel_hi:[1,0] neg_lo:[1,0] neg_hi:[1,0]
    v_exp_f32 v64, v64
    v_exp_f32 v65, v65
    v_exp_f32 v66, v66
    v_exp_f32 v67, v67
    v_exp_f32 v68, v68
    v_exp_f32 v69, v69
    v_exp_f32 v70, v70
    v_exp_f32 v71, v71
    v_pk_add_f32 v[64:65], v[64:65], 1.0 op_sel_hi:[1,0]
    v_pk_add_f32 v[66:67], v[66:67], 1.0 op_sel_hi:[1,0]
    v_pk_add_f32 v[68:69], v[68:69], 1.0 op_sel_hi:[1,0]
    v_pk_add_f32 v[70:71], v[70:71], 1.0 op_sel_hi:[1,0]
    v_rcp_f32 v64, v64
    v_rcp_f32 v65, v65
    v_rcp_f32 v66, v66
    v_rcp_f32 v67, v67
    v_rcp_f32 v68, v68
    v_rcp_f32 v69, v69
    v_rcp_f32 v70, v70
    v_rcp_f32 v71, v71
    v_pk_mul_f32 v[72:73], v[72:73], v[64:65]
    v_pk_mul_f32 v[74:75], v[74:75], v[66:67]
    v_pk_mul_f32 v[76:77], v[76:77], v[68:69]
    v_pk_mul_f32 v[78:79], v[78:79], v[70:71]
    v_cvt_pk_bf16_f32 v64, v72, v73
    v_cvt_pk_bf16_f32 v65, v74, v75
    v_cvt_pk_bf16_f32 v66, v76, v77
    v_cvt_pk_bf16_f32 v67, v78, v79
    s_nop 0
    v_permlane16_swap_b32 v64, v66
    v_permlane16_swap_b32 v65, v67
    v_pk_mul_f32 v[88:89], v[80:81], v[88:89]
    v_pk_mul_f32 v[90:91], v[82:83], v[90:91]
    v_pk_mul_f32 v[92:93], v[84:85], v[92:93]
    v_pk_mul_f32 v[94:95], v[86:87], v[94:95]
    v_pk_mul_f32 v[80:81], v[80:81], s[70:71] op_sel_hi:[1,0] neg_lo:[1,0] neg_hi:[1,0]
    v_pk_mul_f32 v[82:83], v[82:83], s[70:71] op_sel_hi:[1,0] neg_lo:[1,0] neg_hi:[1,0]
    v_pk_mul_f32 v[84:85], v[84:85], s[70:71] op_sel_hi:[1,0] neg_lo:[1,0] neg_hi:[1,0]
    v_pk_mul_f32 v[86:87], v[86:87], s[70:71] op_sel_hi:[1,0] neg_lo:[1,0] neg_hi:[1,0]
    v_exp_f32 v80, v80
    v_exp_f32 v81, v81
    v_exp_f32 v82, v82
    v_exp_f32 v83, v83
    v_exp_f32 v84, v84
    v_exp_f32 v85, v85
    v_exp_f32 v86, v86
    v_exp_f32 v87, v87
    v_pk_add_f32 v[80:81], v[80:81], 1.0 op_sel_hi:[1,0]
    v_pk_add_f32 v[82:83], v[82:83], 1.0 op_sel_hi:[1,0]
    v_pk_add_f32 v[84:85], v[84:85], 1.0 op_sel_hi:[1,0]
    v_pk_add_f32 v[86:87], v[86:87], 1.0 op_sel_hi:[1,0]
    v_rcp_f32 v80, v80
    v_rcp_f32 v81, v81
    v_rcp_f32 v82, v82
    v_rcp_f32 v83, v83
    v_rcp_f32 v84, v84
    v_rcp_f32 v85, v85
    v_rcp_f32 v86, v86
    v_rcp_f32 v87, v87
    v_pk_mul_f32 v[88:89], v[88:89], v[80:81]
    v_pk_mul_f32 v[90:91], v[90:91], v[82:83]
    v_pk_mul_f32 v[92:93], v[92:93], v[84:85]
    v_pk_mul_f32 v[94:95], v[94:95], v[86:87]
    v_cvt_pk_bf16_f32 v80, v88, v89
    v_cvt_pk_bf16_f32 v81, v90, v91
    v_cvt_pk_bf16_f32 v82, v92, v93
    v_cvt_pk_bf16_f32 v83, v94, v95
    s_nop 0
    v_permlane16_swap_b32 v80, v82
    v_permlane16_swap_b32 v81, v83
    v_pk_mul_f32 v[104:105], v[96:97], v[104:105]
    v_pk_mul_f32 v[106:107], v[98:99], v[106:107]
    v_pk_mul_f32 v[108:109], v[100:101], v[108:109]
    v_pk_mul_f32 v[110:111], v[102:103], v[110:111]
    v_pk_mul_f32 v[96:97], v[96:97], s[70:71] op_sel_hi:[1,0] neg_lo:[1,0] neg_hi:[1,0]
    v_pk_mul_f32 v[98:99], v[98:99], s[70:71] op_sel_hi:[1,0] neg_lo:[1,0] neg_hi:[1,0]
    v_pk_mul_f32 v[100:101], v[100:101], s[70:71] op_sel_hi:[1,0] neg_lo:[1,0] neg_hi:[1,0]
    v_pk_mul_f32 v[102:103], v[102:103], s[70:71] op_sel_hi:[1,0] neg_lo:[1,0] neg_hi:[1,0]
    v_exp_f32 v96, v96
    v_exp_f32 v97, v97
    v_exp_f32 v98, v98
    v_exp_f32 v99, v99
    v_exp_f32 v100, v100
    v_exp_f32 v101, v101
    v_exp_f32 v102, v102
    v_exp_f32 v103, v103
    v_pk_add_f32 v[96:97], v[96:97], 1.0 op_sel_hi:[1,0]
    v_pk_add_f32 v[98:99], v[98:99], 1.0 op_sel_hi:[1,0]
    v_pk_add_f32 v[100:101], v[100:101], 1.0 op_sel_hi:[1,0]
    v_pk_add_f32 v[102:103], v[102:103], 1.0 op_sel_hi:[1,0]
    v_rcp_f32 v96, v96
    v_rcp_f32 v97, v97
    v_rcp_f32 v98, v98
    v_rcp_f32 v99, v99
    v_rcp_f32 v100, v100
    v_rcp_f32 v101, v101
    v_rcp_f32 v102, v102
    v_rcp_f32 v103, v103
    v_pk_mul_f32 v[104:105], v[104:105], v[96:97]
    v_pk_mul_f32 v[106:107], v[106:107], v[98:99]
    v_pk_mul_f32 v[108:109], v[108:109], v[100:101]
    v_pk_mul_f32 v[110:111], v[110:111], v[102:103]
    v_cvt_pk_bf16_f32 v96, v104, v105
    v_cvt_pk_bf16_f32 v97, v106, v107
    v_cvt_pk_bf16_f32 v98, v108, v109
    v_cvt_pk_bf16_f32 v99, v110, v111
    s_nop 0
    v_permlane16_swap_b32 v96, v98
    v_permlane16_swap_b32 v97, v99
    v_pk_mul_f32 v[120:121], v[112:113], v[120:121]
    v_pk_mul_f32 v[122:123], v[114:115], v[122:123]
    v_pk_mul_f32 v[124:125], v[116:117], v[124:125]
    v_pk_mul_f32 v[126:127], v[118:119], v[126:127]
    v_pk_mul_f32 v[112:113], v[112:113], s[70:71] op_sel_hi:[1,0] neg_lo:[1,0] neg_hi:[1,0]
    v_pk_mul_f32 v[114:115], v[114:115], s[70:71] op_sel_hi:[1,0] neg_lo:[1,0] neg_hi:[1,0]
    v_pk_mul_f32 v[116:117], v[116:117], s[70:71] op_sel_hi:[1,0] neg_lo:[1,0] neg_hi:[1,0]
    v_pk_mul_f32 v[118:119], v[118:119], s[70:71] op_sel_hi:[1,0] neg_lo:[1,0] neg_hi:[1,0]
    v_exp_f32 v112, v112
    v_exp_f32 v113, v113
    v_exp_f32 v114, v114
    v_exp_f32 v115, v115
    v_exp_f32 v116, v116
    v_exp_f32 v117, v117
    v_exp_f32 v118, v118
    v_exp_f32 v119, v119
    v_pk_add_f32 v[112:113], v[112:113], 1.0 op_sel_hi:[1,0]
    v_pk_add_f32 v[114:115], v[114:115], 1.0 op_sel_hi:[1,0]
    v_pk_add_f32 v[116:117], v[116:117], 1.0 op_sel_hi:[1,0]
    v_pk_add_f32 v[118:119], v[118:119], 1.0 op_sel_hi:[1,0]
    v_rcp_f32 v112, v112
    v_rcp_f32 v113, v113
    v_rcp_f32 v114, v114
    v_rcp_f32 v115, v115
    v_rcp_f32 v116, v116
    v_rcp_f32 v117, v117
    v_rcp_f32 v118, v118
    v_rcp_f32 v119, v119
    v_pk_mul_f32 v[120:121], v[120:121], v[112:113]
    v_pk_mul_f32 v[122:123], v[122:123], v[114:115]
    v_pk_mul_f32 v[124:125], v[124:125], v[116:117]
    v_pk_mul_f32 v[126:127], v[126:127], v[118:119]
    v_cvt_pk_bf16_f32 v112, v120, v121
    v_cvt_pk_bf16_f32 v113, v122, v123
    v_cvt_pk_bf16_f32 v114, v124, v125
    v_cvt_pk_bf16_f32 v115, v126, v127
    s_nop 0
    v_permlane16_swap_b32 v112, v114
    v_permlane16_swap_b32 v113, v115
    s_add_u32 s74, s71, 0
    buffer_store_dwordx4 v[64:67], v1, s[40:43], s74 offen sc1
    s_add_u32 s74, s71, 114688
    buffer_store_dwordx4 v[80:83], v1, s[40:43], s74 offen sc1
    s_add_u32 s74, s71, 229376
    buffer_store_dwordx4 v[96:99], v1, s[40:43], s74 offen sc1
    s_add_u32 s74, s71, 344064
    buffer_store_dwordx4 v[112:115], v1, s[40:43], s74 offen sc1
    s_waitcnt vmcnt(0)
    s_barrier
    s_cmp_eq_u32 s60, 7
    s_cbranch_scc0 L_no6
    s_add_u32 s74, s3, 0
    buffer_store_dword v18, v17, s[40:43], s74 offen sc1
    s_add_u32 s74, s3, 3584
    buffer_store_dword v18, v17, s[40:43], s74 offen sc1
L_no6:
    s_branch L_pre
L_janitor:
    s_sub_u32 s72, s63, 154
    s_lshl_b32 s64, s72, 3
    s_add_u32 s73, s64, s60
    s_mul_i32 s64, s73, 5120
    s_add_u32 s64, s64, 0x990000
    s_add_u32 s65, s64, 4096
    v_mov_b32 v4, 0
    v_mov_b32 v5, 0
    v_mov_b32 v6, 0
    v_mov_b32 v7, 0
    s_mov_b32 s30, 0x1c0000
    s_mov_b32 s31, 0x20000
    s_mov_b32 s42, 0xa00000
    s_mov_b32 s43, 0x20000
    s_mov_b32 s58, 0x100
    s_mov_b32 s59, 0x20000
    s_waitcnt lgkmcnt(0)
    s_mov_b64 s[28:29], s[4:5]
    s_mov_b64 s[40:41], s[26:27]
    s_mov_b64 s[56:57], s[24:25]
    buffer_store_dwordx4 v[4:7], v1, s[40:43], s64 offen offset:0 sc1
    buffer_store_dwordx4 v[4:7], v1, s[40:43], s64 offen offset:1024 sc1
    buffer_store_dwordx4 v[4:7], v1, s[40:43], s64 offen offset:2048 sc1
    buffer_store_dwordx4 v[4:7], v1, s[40:43], s64 offen offset:3072 sc1
    buffer_store_dwordx4 v[4:7], v1, s[40:43], s65 offen sc1
    s_lshl_b32 s64, s73, 10
    s_add_u32 s64, s64, 0x900000
    v_mov_b32 v32, -1
    v_mov_b32 v33, -1
    v_mov_b32 v34, -1
    v_mov_b32 v35, -1
    buffer_store_dwordx4 v[32:35], v1, s[40:43], s64 offen sc1
    s_add_u32 s64, s64, 49152
    buffer_store_dwordx4 v[32:35], v1, s[40:43], s64 offen sc1
    s_add_u32 s64, s64, 49152
    buffer_store_dwordx4 v[32:35], v1, s[40:43], s64 offen sc1
    s_add_u32 s64, s64, 49152
    buffer_store_dwordx4 v[32:35], v1, s[40:43], s64 offen sc1
    s_add_u32 s64, s64, 49152
    buffer_store_dwordx4 v[32:35], v1, s[40:43], s64 offen sc1
    s_add_u32 s64, s64, 49152
    buffer_store_dwordx4 v[32:35], v1, s[40:43], s64 offen sc1
    s_add_u32 s64, s64, 49152
    buffer_store_dwordx4 v[32:35], v1, s[40:43], s64 offen sc1
    s_add_u32 s64, s64, 49152
    buffer_store_dwordx4 v[32:35], v1, s[40:43], s64 offen sc1
    s_add_u32 s64, s64, 49152
    buffer_store_dwordx4 v[32:35], v1, s[40:43], s64 offen sc1
    s_add_u32 s64, s64, 49152
    buffer_store_dwordx4 v[32:35], v1, s[40:43], s64 offen sc1
    s_add_u32 s64, s64, 49152
    buffer_store_dwordx4 v[32:35], v1, s[40:43], s64 offen sc1
    s_add_u32 s64, s64, 49152
    s_mov_b32 s44, s18
    s_mov_b32 s45, s19
    s_mov_b32 s46, 0x188000
    s_mov_b32 s47, 0x20000
    s_mov_b32 s48, s10
    s_mov_b32 s49, s11
    s_mov_b32 s50, 0x62000
    s_mov_b32 s51, 0x20000
    s_mov_b32 s52, s22
    s_mov_b32 s53, s23
    s_mov_b32 s54, 0x1c0000
    s_mov_b32 s55, 0x20000
    s_mul_i32 s63, s62, 37
    s_lshr_b32 s63, s63, 8
    s_mul_i32 s82, s63, 7
    s_sub_u32 s82, s62, s82
    s_mul_i32 s88, s82, 1
    s_mul_i32 s64, s63, 0
    s_add_u32 s88, s88, s64
    s_add_u32 s88, s88, s60
    s_and_b32 s88, s88, 7
    s_mul_i32 s64, s61, 3
    s_add_u32 s64, s64, s63
    s_sub_u32 s65, s64, 12
    s_cmp_eq_u32 s63, 3
    s_cselect_b32 s65, s61, s65
    s_cselect_b32 s64, 20, s64
    s_mul_i32 s80, s65, 6
    s_add_u32 s80, s80, 2
    s_lshl_b32 s66, s65, 1
    s_add_u32 s66, s66, 40
    s_cmp_ge_i32 s65, 10
    s_cselect_b32 s80, s66, s80
    s_lshr_b32 s65, s64, 1
    s_mul_i32 s65, s65, 6
    s_and_b32 s66, s64, 1
    s_add_u32 s65, s65, s66
    s_cmp_lt_u32 s64, 20
    s_cselect_b32 s80, s65, s80
    s_cselect_b32 s66, 4, 1
    s_add_u32 s81, s80, s66
    s_mul_i32 s4, s60, 6144
    s_lshl_b32 s27, s60, 13
    s_lshl_b32 s63, s82, 7
    s_mul_i32 s5, s88, 200704
    s_add_u32 s5, s5, s63
    s_mul_i32 s10, s88, 50176
    s_add_u32 s10, s10, s63
    s_cmp_ge_u32 s60, 4
    s_cselect_b32 s23, s81, s80
    s_mul_i32 s23, s23, 28672
    s_add_u32 s23, s23, s63
    s_and_b32 s63, s60, 3
    s_mul_i32 s63, s63, 7168
    s_add_u32 s23, s23, s63
    s_mul_i32 s63, s88, 14
    s_mul_i32 s64, s80, 112
    s_add_u32 s64, s64, s63
    s_lshl_b32 s83, s64, 10
    s_mul_i32 s11, s80, 1792
    s_add_u32 s11, s11, 0x990000
    s_lshl_b32 s64, s80, 3
    s_add_u32 s64, s64, s88
    s_lshl_b32 s85, s64, 12
    s_add_u32 s85, s85, 0x700000
    s_mul_i32 s64, s81, 112
    s_add_u32 s64, s64, s63
    s_lshl_b32 s84, s64, 10
    s_mul_i32 s12, s81, 1792
    s_add_u32 s12, s12, 0x990000
    s_lshl_b32 s64, s81, 3
    s_add_u32 s64, s64, s88
    s_lshl_b32 s86, s64, 12
    s_add_u32 s86, s86, 0x700000
    v_lshlrev_b32 v13, 3, v0
    v_min_u32 v13, 13, v13
    v_add_u32 v13, s63, v13
    s_lshl_b32 s63, s88, 7
    s_add_u32 s13, s63, 0x9ac000
    s_lshl_b32 s63, s80, 10
    s_lshl_b32 s64, s81, 10
    v_mov_b32 v14, s64
    v_mov_b32 v28, s63
    v_cmp_eq_u32 vcc, 0, v0
    v_lshrrev_b32 v13, 3, v13
    v_lshlrev_b32 v13, 7, v13
    v_cndmask_b32 v14, v14, v28, vcc
    v_bfe_u32 v28, v0, 4, 1
    v_lshlrev_b32 v28, 6, v28
    v_and_b32 v29, 0x70, v1
    v_xor_b32 v28, v28, v29
    v_lshrrev_b32 v29, 3, v0
    v_mul_u32_u24 v29, 896, v29
    v_add_u32 v10, v28, v29
    v_bfe_u32 v28, v0, 2, 2
    v_lshrrev_b32 v29, 5, v0
    v_lshl_or_b32 v15, v29, 26, v10
    v_lshl_add_u32 v29, v29, 2, v28
    v_lshlrev_b32 v29, 7, v29
    v_bfe_u32 v28, v0, 3, 1
    v_lshl_add_u32 v29, v28, 6, v29
    v_bfe_u32 v28, v0, 4, 1
    v_lshl_add_u32 v29, v28, 5, v29
    v_and_b32 v28, 1, v0
    v_lshl_add_u32 v29, v28, 4, v29
    v_bfe_u32 v28, v0, 1, 1
    v_lshl_add_u32 v29, v28, 3, v29
    v_add_u32 v11, s4, v29
    v_xor_b32 v12, 64, v11
    v_cmp_gt_u32 vcc, 3, v0
    v_mov_b32 v28, 0x4000000
    s_nop 0
    v_cndmask_b32 v13, v28, v13, vcc
    v_cmp_gt_u32 vcc, 2, v0
    v_mov_b32 v28, 0x4000000
    s_nop 0
    v_cndmask_b32 v14, v28, v14, vcc
    s_lshl_b32 s63, s72, 2
    s_lshl_b32 s64, s60, 12
    s_add_u32 s63, s63, s64
    s_waitcnt vmcnt(0)
    s_barrier
    buffer_store_dword v18, v17, s[56:59], s63 offen sc1
    v_lshlrev_b32 v2, 7, v0
    v_lshlrev_b32 v3, 7, v0
    s_mul_i32 s63, s60, 200704
    s_mul_i32 s64, s72, 4864
    s_add_u32 s63, s63, s64
    s_mul_i32 s64, s73, 8448
    v_cmp_gt_u32 vcc, 38, v0
    v_mov_b32 v28, 0x4000000
    s_nop 0
    v_cndmask_b32 v2, v28, v2, vcc
    v_cmp_gt_u32 vcc, 33, v0
    v_mov_b32 v28, 0x4000000
    s_nop 0
    v_cndmask_b32 v3, v28, v3, vcc
    buffer_load_dword v32, v2, s[44:47], s63 offen
    s_add_u32 s63, s63, 28672
    s_waitcnt vmcnt(1)
    buffer_load_dword v33, v2, s[44:47], s63 offen
    s_add_u32 s63, s63, 28672
    s_waitcnt vmcnt(1)
    buffer_load_dword v34, v2, s[44:47], s63 offen
    s_add_u32 s63, s63, 28672
    s_waitcnt vmcnt(1)
    buffer_load_dword v35, v2, s[44:47], s63 offen
    s_add_u32 s63, s63, 28672
    s_waitcnt vmcnt(1)
    buffer_load_dword v36, v3, s[48:51], s64 offen
    s_add_u32 s64, s64, 4224
    s_waitcnt vmcnt(1)
    buffer_load_dword v37, v3, s[48:51], s64 offen
    s_add_u32 s64, s64, 4224
    s_waitcnt vmcnt(1)
    buffer_load_dword v38, v2, s[44:47], s63 offen
    s_add_u32 s63, s63, 28672
    s_waitcnt vmcnt(1)
    buffer_load_dword v39, v2, s[44:47], s63 offen
    s_add_u32 s63, s63, 28672
    s_waitcnt vmcnt(1)
    buffer_load_dword v40, v2, s[44:47], s63 offen
    s_add_u32 s63, s63, 28672
    s_waitcnt vmcnt(1)
    s_add_u32 m0, s4, 49152
    s_add_u32 s74, s5, 0
    buffer_load_dwordx4 v10, s[44:47], s74 offen lds
    s_add_u32 m0, s4, 50176
    s_add_u32 s74, s5, 7168
    buffer_load_dwordx4 v10, s[44:47], s74 offen lds
    s_add_u32 m0, s4, 51200
    s_add_u32 s74, s5, 14336
    buffer_load_dwordx4 v10, s[44:47], s74 offen lds
    s_add_u32 m0, s4, 52224
    s_add_u32 s74, s5, 21504
    buffer_load_dwordx4 v10, s[44:47], s74 offen lds
    s_add_u32 m0, s4, 53248
    s_add_u32 s74, s5, 28672
    buffer_load_dwordx4 v10, s[44:47], s74 offen lds
    s_add_u32 m0, s4, 54272
    s_add_u32 s74, s5, 35840
    buffer_load_dwordx4 v10, s[44:47], s74 offen lds
    s_add_u32 m0, s4, 0
    s_add_u32 s74, s5, 43008
    buffer_load_dwordx4 v10, s[44:47], s74 offen lds
    s_add_u32 m0, s4, 1024
    s_add_u32 s74, s5, 50176
    buffer_load_dwordx4 v10, s[44:47], s74 offen lds
    v_lshrrev_b32 v19, 3, v0
    v_lshlrev_b32 v19, 8, v19
    v_lshl_add_u32 v19, v0, 2, v19
    buffer_load_dword v16, v19, s[56:59], 0 offen sc1
    s_waitcnt vmcnt(0)
    v_cmp_eq_u32 vcc, 0, v16
    s_nop 1
    s_and_b32 s74, vcc_lo, 63
    s_cbranch_scc0 L_ok7
    s_mov_b32 s75, 40000
L_sp7:
    s_sleep 2
    buffer_load_dword v16, v19, s[56:59], 0 offen sc1
    s_waitcnt vmcnt(0)
    v_cmp_eq_u32 vcc, 0, v16
    s_sub_u32 s75, s75, 1
    s_cmp_eq_u32 s75, 0
    s_cbranch_scc1 L_ok7
    s_and_b32 s74, vcc_lo, 63
    s_cbranch_scc1 L_sp7
L_ok7:
L_pre:
    ds_read_b64_tr_b16 v[20:21], v11 offset:49152
    ds_read_b64_tr_b16 v[22:23], v11 offset:50176
    ds_read_b64_tr_b16 v[24:25], v12 offset:49152
    ds_read_b64_tr_b16 v[26:27], v12 offset:50176
    ds_read_b64_tr_b16 v[80:81], v11 offset:51200
    ds_read_b64_tr_b16 v[82:83], v11 offset:52224
    ds_read_b64_tr_b16 v[84:85], v12 offset:51200
    ds_read_b64_tr_b16 v[86:87], v12 offset:52224
    ds_read_b64_tr_b16 v[88:89], v11 offset:53248
    ds_read_b64_tr_b16 v[90:91], v11 offset:54272
    ds_read_b64_tr_b16 v[92:93], v12 offset:53248
    ds_read_b64_tr_b16 v[94:95], v12 offset:54272
    ds_read_b64_tr_b16 v[144:145], v11 offset:0
    ds_read_b64_tr_b16 v[146:147], v11 offset:1024
    ds_read_b64_tr_b16 v[148:149], v12 offset:0
    ds_read_b64_tr_b16 v[150:151], v12 offset:1024
    s_waitcnt lgkmcnt(12)
    s_add_u32 m0, s4, 49152
    s_add_u32 s74, s5, 86016
    buffer_load_dwordx4 v10, s[44:47], s74 offen lds
    s_add_u32 m0, s4, 50176
    s_add_u32 s74, s5, 93184
    buffer_load_dwordx4 v10, s[44:47], s74 offen lds
    s_waitcnt lgkmcnt(8)
    s_add_u32 m0, s4, 51200
    s_add_u32 s74, s5, 100352
    buffer_load_dwordx4 v10, s[44:47], s74 offen lds
    s_add_u32 m0, s4, 52224
    s_add_u32 s74, s5, 107520
    buffer_load_dwordx4 v10, s[44:47], s74 offen lds
    s_waitcnt lgkmcnt(4)
    s_add_u32 m0, s4, 53248
    s_add_u32 s74, s5, 114688
    buffer_load_dwordx4 v10, s[44:47], s74 offen lds
    s_add_u32 m0, s4, 54272
    s_add_u32 s74, s5, 121856
    buffer_load_dwordx4 v10, s[44:47], s74 offen lds
    s_waitcnt lgkmcnt(0)
    s_add_u32 m0, s4, 0
    s_add_u32 s74, s5, 129024
    buffer_load_dwordx4 v10, s[44:47], s74 offen lds
    s_add_u32 m0, s4, 1024
    s_add_u32 s74, s5, 136192
    buffer_load_dwordx4 v10, s[44:47], s74 offen lds
    s_waitcnt vmcnt(0) lgkmcnt(0)
    s_branch L_stage
L_q:
    v_lshrrev_b32 v1, 6, v0
    v_and_b32 v0, 63, v0
    v_readfirstlane_b32 s60, v1
    s_and_b32 s61, s2, 7
    s_lshr_b32 s62, s2, 3
    s_mov_b32 s70, 0x3fb8aa3b
    s_and_b32 s48, s48, 0xffffff00
    s_mov_b32 s50, L_code_end-gated_mix__linear_kernel_hedgehog__glu_gated_swiglu__prompt_kernel
    s_mov_b32 s51, 0x20000
    s_and_b32 s63, s62, 7
    s_lshl_b32 s63, s63, 3
    s_add_u32 s63, s63, s60
    s_mul_i32 s63, s63, 768
    v_min_u32 v2, 5, v0
    v_lshlrev_b32 v2, 7, v2
    buffer_load_dword v16, v2, s[48:51], s63 offen
    v_mov_b32 v18, 1
    v_cmp_eq_u32 vcc, 0, v0
    v_mov_b32 v17, 0x4000000
    v_lshlrev_b32 v1, 4, v0
    s_lshl_b32 s69, s60, 10
    v_cndmask_b32 v17, v17, v0, vcc
    s_and_b32 s63, s60, 1
    s_lshl_b32 s63, s63, 2
    v_lshrrev_b32 v28, 4, v0
    v_add_u32 v28, s63, v28
    v_and_b32 v29, 7, v0
    v_xor_b32 v28, v28, v29
    v_lshlrev_b32 v28, 4, v28
    v_lshrrev_b32 v29, 3, v0
    v_mul_u32_u24 v29, 896, v29
    v_add_u32 v4, v28, v29
    s_lshr_b32 s75, s61, 2
    s_xor_b32 s75, s75, s61
    s_and_b32 s75, s75, 1
    s_mul_i32 s75, s75, 4
    s_setprio 1
    s_sub_u32 s63, s2, 224
    s_lshl_b32 s63, s63, 3
    s_add_u32 s63, s63, s60
    s_and_b32 s64, s63, 1
    s_lshr_b32 s65, s63, 1
    s_mul_i32 s66, s64, 4
    v_lshrrev_b32 v28, 4, v0
    v_and_b32 v29, 15, v0
    v_mov_b32 v31, 0x4000000
    s_lshl_b32 s80, s65, 4
    v_add_u32 v30, s80, v29
    v_mul_u32_u24 v32, 896, v30
    s_lshr_b32 s80, s65, 1
    s_and_b32 s81, s65, 1
    s_mul_i32 s82, s81, 14
    v_add_u32 v30, s82, v29
    v_lshlrev_b32 v33, 7, v30
    s_mul_i32 s82, s81, 7
    s_add_u32 s82, s82, 7
    v_add_u32 v30, s82, v29
    v_lshlrev_b32 v34, 7, v30
    v_cmp_gt_u32 vcc, 16, v0
    s_nop 1
    v_cndmask_b32 v32, v31, v32, vcc
    v_cmp_gt_u32 vcc, 14, v0
    s_nop 1
    v_cndmask_b32 v33, v31, v33, vcc
    v_cmp_gt_u32 vcc, 7, v0
    s_nop 1
    v_cndmask_b32 v34, v31, v34, vcc
    s_mov_b32 s30, 0x1c0000
    s_mov_b32 s31, 0x20000
    s_mov_b32 s38, 0x188000
    s_mov_b32 s39, 0x20000
    s_mov_b32 s54, 0x188000
    s_mov_b32 s55, 0x20000
    s_mov_b32 s34, 0x126000
    s_mov_b32 s35, 0x20000
    s_mov_b32 s46, 0x380
    s_mov_b32 s47, 0x20000
    s_mov_b32 s42, 0xa00000
    s_mov_b32 s43, 0x20000
    s_mov_b32 s58, 0x100
    s_mov_b32 s59, 0x20000
    s_waitcnt lgkmcnt(0)
    s_mov_b64 s[28:29], s[4:5]
    s_mov_b64 s[36:37], s[14:15]
    s_mov_b64 s[52:53], s[16:17]
    s_mov_b64 s[32:33], s[6:7]
    s_mov_b64 s[44:45], s[20:21]
    s_mov_b64 s[40:41], s[26:27]
    s_mov_b64 s[56:57], s[24:25]
    s_add_u32 s63, s66, 1
    s_lshl_b32 s64, s63, 7
    s_lshl_b32 s63, s63, 6
    s_add_u32 s63, s63, s80
    s_cmp_ge_u32 s63, 448
    s_cselect_b32 s64, 0x4000000, s64
    s_mul_i32 s82, s63, 3584
    s_mul_i32 s63, s63, 2688
    buffer_load_dword v40, v33, s[36:39], s82 offen
    buffer_load_dword v41, v33, s[52:55], s82 offen
    buffer_load_dword v42, v32, s[28:31], s64 offen
    buffer_load_dword v43, v34, s[32:35], s63 offen
    s_barrier
    s_add_u32 s63, s66, 2
    s_lshl_b32 s64, s63, 7
    s_lshl_b32 s63, s63, 6
    s_add_u32 s63, s63, s80
    s_cmp_ge_u32 s63, 448
    s_cselect_b32 s64, 0x4000000, s64
    s_mul_i32 s82, s63, 3584
    s_mul_i32 s63, s63, 2688
    buffer_load_dword v44, v33, s[36:39], s82 offen
    buffer_load_dword v45, v33, s[52:55], s82 offen
    buffer_load_dword v46, v32, s[28:31], s64 offen
    buffer_load_dword v47, v34, s[32:35], s63 offen
    s_lshr_b32 s72, s61, 2
    s_lshl_b32 s72, s72, 2
    s_and_b32 s63, s62, 3
    s_add_u32 s72, s72, s63
    s_and_b32 s73, s61, 3
    s_lshl_b32 s64, s73, 1
    s_add_u32 s64, s64, s72
    s_mul_i32 s64, s64, 2
    s_add_u32 s64, s64, s60
    s_and_b32 s64, s64, 7
    s_lshl_b32 s69, s64, 10
    s_mul_i32 s67, s64, 10752
    s_mul_i32 s63, s73, 224
    s_add_u32 s67, s67, s63
    s_mul_i32 s68, s72, 229376
    s_mul_i32 s63, s64, 7168
    s_add_u32 s68, s68, s63
    v_lshrrev_b32 v28, 4, v0
    v_lshlrev_b32 v29, 2, v28
    v_and_b32 v30, 15, v0
    v_xor_b32 v29, v29, v30
    v_mul_u32_u24 v28, 2688, v28
    v_cmp_lt_u32 vcc, 13, v29
    v_lshl_add_u32 v2, v29, 4, v28
    v_mov_b32 v29, 0x4000000
    v_cndmask_b32 v2, v2, v29, vcc
    s_lshl_b32 s63, s60, 3
    v_and_b32 v28, 7, v0
    v_add_u32 v28, s63, v28
    v_lshrrev_b32 v31, 3, v0
    v_add_u32 v29, s75, v31
    v_subrev_u32 v30, 7, v29
    v_min_u32 v29, v29, v30
    v_lshlrev_b32 v29, 7, v29
    v_lshl_add_u32 v29, v28, 1, v29
    buffer_load_ushort v12, v29, s[44:47], 0 offen
    v_and_b32 v30, 3, v28
    v_lshlrev_b32 v30, 6, v30
    v_lshl_add_u32 v30, v31, 3, v30
    v_lshl_add_u32 v30, v28, 8, v30
    v_add_u32 v10, 147456, v30
    s_mov_b32 s24, s75
    s_mul_i32 s25, s24, 172032
    s_add_u32 s25, s25, s67
    s_lshl_b32 s26, s24, 7
    s_add_u32 s26, s26, s68
    s_add_u32 m0, s69, 0
    s_add_u32 s74, s25, 0
    buffer_load_dwordx4 v2, s[32:35], s74 offen lds
    s_add_u32 m0, s69, 16384
    s_add_u32 s74, s26, 0
    buffer_load_dwordx4 v4, s[28:31], s74 offen lds
    s_add_u32 m0, s69, 32768
    s_add_u32 s74, s26, 114688
    buffer_load_dwordx4 v4, s[28:31], s74 offen lds
    s_add_u32 m0, s69, 8192
    s_add_u32 s74, s25, 86016
    buffer_load_dwordx4 v2, s[32:35], s74 offen lds
    s_add_u32 m0, s69, 24576
    s_add_u32 s74, s26, 57344
    buffer_load_dwordx4 v4, s[28:31], s74 offen lds
    s_add_u32 m0, s69, 40960
    s_add_u32 s74, s26, 172032
    buffer_load_dwordx4 v4, s[28:31], s74 offen lds
    s_mov_b32 s36, s8
    s_mov_b32 s37, s9
    s_mov_b32 s38, 0x6200
    s_mov_b32 s39, 0x20000
    s_mul_i32 s71, s73, 6272
    s_add_u32 s71, s71, s69
    s_cmp_lt_u32 s69, 7168
    s_cselect_b32 s71, s71, 0x4000000
    s_and_b32 s64, s60, 3
    s_lshl_b32 s64, s64, 13
    s_lshr_b32 s66, s60, 2
    v_bfe_u32 v28, v0, 1, 3
    v_lshrrev_b32 v29, 5, v0
    v_xor_b32 v28, v28, v29
    v_lshlrev_b32 v28, 4, v28
    v_and_b32 v29, 31, v0
    v_lshl_add_u32 v6, v29, 7, v28
    v_add_u32 v6, s64, v6
    v_xor_b32 v7, 32, v6
    v_xor_b32 v8, 64, v6
    v_xor_b32 v9, 96, v6
    v_bfe_u32 v28, v0, 2, 2
    v_bfe_u32 v29, v0, 4, 1
    v_and_b32 v30, 3, v0
    v_lshl_add_u32 v29, v29, 2, v30
    v_cmp_eq_u32 vcc, 7, v29
    v_lshlrev_b32 v30, 3, v29
    v_lshrrev_b32 v31, 5, v0
    v_lshl_add_u32 v31, v31, 3, v28
    v_lshlrev_b32 v31, 8, v31
    v_lshlrev_b32 v28, 6, v28
    s_mul_i32 s63, s66, 112
    v_add_u32 v3, s63, v30
    v_add_u32 v5, 56, v3
    v_mov_b32 v30, 147456
    v_cndmask_b32 v3, v3, v30, vcc
    v_cndmask_b32 v5, v5, v30, vcc
    v_mov_b32 v14, 0x18000
    v_mov_b32 v15, 0xffff4000
    v_cndmask_b32_e64 v14, v14, 8, vcc
    v_cndmask_b32_e64 v15, v15, 8, vcc
    v_mov_b32 v13, 0
    v_xor_b32 v3, v3, v28
    v_xor_b32 v5, v5, v28
    v_add_u32 v3, v3, v31
    v_add_u32 v5, v5, v31
    s_barrier
    s_add_u32 s24, s24, 1
    s_cmp_eq_u32 s24, 7
    s_cselect_b32 s24, 0, s24
    s_mul_i32 s25, s24, 172032
    s_add_u32 s25, s25, s67
    s_lshl_b32 s26, s24, 7
    s_add_u32 s26, s26, s68
    s_add_u32 m0, s69, 98304
    s_add_u32 s74, s25, 0
    buffer_load_dwordx4 v2, s[32:35], s74 offen lds
    s_add_u32 m0, s69, 114688
    s_add_u32 s74, s26, 0
    buffer_load_dwordx4 v4, s[28:31], s74 offen lds
    s_add_u32 m0, s69, 131072
    s_add_u32 s74, s26, 114688
    buffer_load_dwordx4 v4, s[28:31], s74 offen lds
    s_add_u32 m0, s69, 106496
    s_add_u32 s74, s25, 86016
    buffer_load_dwordx4 v2, s[32:35], s74 offen lds
    s_add_u32 m0, s69, 122880
    s_add_u32 s74, s26, 57344
    buffer_load_dwordx4 v4, s[28:31], s74 offen lds
    s_add_u32 m0, s69, 139264
    s_add_u32 s74, s26, 172032
    buffer_load_dwordx4 v4, s[28:31], s74 offen lds
    s_waitcnt vmcnt(12)
    ds_write_b64 v10, v[12:13]
    s_waitcnt vmcnt(6) lgkmcnt(0)
    s_barrier
    ds_read_b64_tr_b16 v[32:33], v3 offset:0
    ds_read_b64_tr_b16 v[34:35], v3 offset:1024
    ds_read_b128 v[48:51], v6 offset:16384
    ds_read_b128 v[52:55], v6 offset:20480
    ds_read_b64_tr_b16 v[36:37], v5 offset:0
    ds_read_b64_tr_b16 v[38:39], v5 offset:1024
    s_waitcnt lgkmcnt(3)
    v_mfma_f32_32x32x16_bf16 v[64:79], v[32:35], v[48:51], 0
    ds_read_b64_tr_b16 v[40:41], v3 offset:4096
    ds_read_b64_tr_b16 v[42:43], v3 offset:5120
    s_lshr_b32 s18, s60, 2
    s_and_b32 s19, s60, 3
    s_lshl_b32 s22, s73, 1
    s_waitcnt lgkmcnt(4)
    v_mfma_f32_32x32x16_bf16 v[80:95], v[32:35], v[52:55], 0
    ds_read_b128 v[56:59], v7 offset:16384
    ds_read_b128 v[60:63], v7 offset:20480
    s_add_u32 s24, s24, 1
    s_cmp_eq_u32 s24, 7
    s_cselect_b32 s24, 0, s24
    s_mul_i32 s25, s24, 172032
    s_add_u32 s25, s25, s67
    s_lshl_b32 s26, s24, 7
    s_add_u32 s26, s26, s68
    s_add_u32 s22, s22, s18
    s_lshl_b32 s22, s22, 1
    s_mul_i32 s66, s72, 1
    s_waitcnt lgkmcnt(4)
    v_mfma_f32_32x32x16_bf16 v[96:111], v[36:39], v[48:51], 0
    ds_read_b64_tr_b16 v[44:45], v5 offset:4096
    ds_read_b64_tr_b16 v[46:47], v5 offset:5120
    s_add_u32 s66, s66, s19
    s_and_b32 s66, s66, 3
    s_lshl_b32 s63, s73, 2
    v_mfma_f32_32x32x16_bf16 v[112:127], v[36:39], v[52:55], 0
    s_add_u32 m0, s69, 49152
    s_add_u32 s74, s25, 0
    buffer_load_dwordx4 v2, s[32:35], s74 offen lds
    s_add_u32 s63, s63, s66
    s_lshl_b32 s63, s63, 1
    s_lshl_b32 s64, s63, 14
    s_waitcnt lgkmcnt(3)
    v_mfma_f32_32x32x16_bf16 v[64:79], v[40:43], v[56:59], v[64:79]
    ds_read_b64_tr_b16 v[32:33], v3 offset:8192
    ds_read_b64_tr_b16 v[34:35], v3 offset:9216
    s_add_u32 s83, s64, 0x900000
    s_add_u32 s84, s83, 8192
    s_lshl_b32 s64, s63, 10
    s_waitcnt lgkmcnt(4)
    v_mfma_f32_32x32x16_bf16 v[80:95], v[40:43], v[60:63], v[80:95]
    ds_read_b128 v[48:51], v8 offset:16384
    ds_read_b128 v[52:55], v8 offset:20480
    s_add_u32 m0, s69, 65536
    s_add_u32 s74, s26, 0
    buffer_load_dwordx4 v4, s[28:31], s74 offen lds
    s_add_u32 s11, s64, 0x9bc000
    s_and_b32 s82, s72, 3
    s_mul_i32 s82, s82, 0
    s_waitcnt lgkmcnt(4)
    v_mfma_f32_32x32x16_bf16 v[96:111], v[44:47], v[56:59], v[96:111]
    ds_read_b64_tr_b16 v[36:37], v5 offset:8192
    ds_read_b64_tr_b16 v[38:39], v5 offset:9216
    s_add_u32 m0, s69, 81920
    s_add_u32 s74, s26, 114688
    buffer_load_dwordx4 v4, s[28:31], s74 offen lds
    v_mfma_f32_32x32x16_bf16 v[112:127], v[44:47], v[60:63], v[112:127]
    s_add_u32 m0, s69, 57344
    s_add_u32 s74, s25, 86016
    buffer_load_dwordx4 v2, s[32:35], s74 offen lds
    v_add_u32 v23, s82, v0
    v_and_b32 v28, 3, v23
    v_and_b32 v23, 12, v0
    v_or_b32 v23, v23, v28
    v_lshlrev_b32 v23, 7, v23
    v_bfe_u32 v28, v0, 3, 1
    s_waitcnt lgkmcnt(3)
    v_mfma_f32_32x32x16_bf16 v[64:79], v[32:35], v[48:51], v[64:79]
    ds_read_b64_tr_b16 v[40:41], v3 offset:12288
    ds_read_b64_tr_b16 v[42:43], v3 offset:13312
    s_add_u32 m0, s69, 73728
    s_add_u32 s74, s26, 57344
    buffer_load_dwordx4 v4, s[28:31], s74 offen lds
    v_and_b32 v29, 3, v0
    v_lshl_add_u32 v24, v28, 2, v29
    v_bfe_u32 v28, v0, 2, 1
    s_waitcnt lgkmcnt(4)
    v_mfma_f32_32x32x16_bf16 v[80:95], v[32:35], v[52:55], v[80:95]
    ds_read_b128 v[56:59], v9 offset:16384
    ds_read_b128 v[60:63], v9 offset:20480
    v_bfe_u32 v29, v0, 4, 2
    v_lshlrev_b32 v28, 1, v28
    v_xor_b32 v28, v28, v29
    s_waitcnt lgkmcnt(4)
    v_mfma_f32_32x32x16_bf16 v[96:111], v[36:39], v[48:51], v[96:111]
    ds_read_b64_tr_b16 v[44:45], v5 offset:12288
    ds_read_b64_tr_b16 v[46:47], v5 offset:13312
    s_add_u32 m0, s69, 90112
    s_add_u32 s74, s26, 172032
    buffer_load_dwordx4 v4, s[28:31], s74 offen lds
    v_mfma_f32_32x32x16_bf16 v[112:127], v[36:39], v[52:55], v[112:127]
    v_cmp_eq_u32 s[78:79], 0, v28
    v_and_b32 v30, 1, v24
    v_lshlrev_b32 v30, 4, v30
    v_mov_b32 v31, 0x3f80
    v_lshlrev_b32 v30, v30, v31
    s_waitcnt vmcnt(6) lgkmcnt(0)
    s_barrier
    v_add_u32 v3, v14, v3
    v_add_u32 v5, v14, v5
    v_add_u32 v6, 0x18000, v6
    v_add_u32 v7, 0x18000, v7
    v_add_u32 v8, 0x18000, v8
    v_add_u32 v9, 0x18000, v9
    v_mfma_f32_32x32x16_bf16 v[64:79], v[40:43], v[56:59], v[64:79]
    ds_read_b64_tr_b16 v[32:33], v3 offset:0
    ds_read_b64_tr_b16 v[34:35], v3 offset:1024
    v_cndmask_b32_e64 v30, 0, v30, s[78:79]
    v_lshrrev_b32 v31, 1, v24
    v_cmp_eq_u32 vcc, 0, v31
    v_mfma_f32_32x32x16_bf16 v[80:95], v[40:43], v[60:63], v[80:95]
    ds_read_b128 v[48:51], v6 offset:16384
    ds_read_b128 v[52:55], v6 offset:20480
    v_mfma_f32_32x32x16_bf16 v[96:111], v[44:47], v[56:59], v[96:111]
    ds_read_b64_tr_b16 v[36:37], v5 offset:0
    ds_read_b64_tr_b16 v[38:39], v5 offset:1024
    s_add_u32 s24, s24, 1
    s_cmp_eq_u32 s24, 7
    s_cselect_b32 s24, 0, s24
    s_mul_i32 s25, s24, 172032
    s_add_u32 s25, s25, s67
    s_lshl_b32 s26, s24, 7
    s_add_u32 s26, s26, s68
    v_cndmask_b32_e64 v176, 0, v30, vcc
    v_cmp_eq_u32 vcc, 1, v31
    v_mfma_f32_32x32x16_bf16 v[112:127], v[44:47], v[60:63], v[112:127]
    s_nop 0
    v_cndmask_b32_e64 v177, 0, v30, vcc
    v_cmp_eq_u32 vcc, 2, v31
    s_nop 1
    v_cndmask_b32_e64 v178, 0, v30, vcc
    v_cmp_eq_u32 vcc, 3, v31
    s_waitcnt lgkmcnt(3)
    v_mfma_f32_32x32x16_bf16 v[64:79], v[32:35], v[48:51], v[64:79]
    ds_read_b64_tr_b16 v[40:41], v3 offset:4096
    ds_read_b64_tr_b16 v[42:43], v3 offset:5120
    v_cndmask_b32_e64 v179, 0, v30, vcc
    v_cmp_eq_u32 s[78:79], 1, v28
    s_waitcnt lgkmcnt(4)
    v_mfma_f32_32x32x16_bf16 v[80:95], v[32:35], v[52:55], v[80:95]
    ds_read_b128 v[56:59], v7 offset:16384
    ds_read_b128 v[60:63], v7 offset:20480
    s_add_u32 m0, s69, 0
    s_add_u32 s74, s25, 0
    buffer_load_dwordx4 v2, s[32:35], s74 offen lds
    v_and_b32 v30, 1, v24
    v_lshlrev_b32 v30, 4, v30
    s_waitcnt lgkmcnt(4)
    v_mfma_f32_32x32x16_bf16 v[96:111], v[36:39], v[48:51], v[96:111]
    ds_read_b64_tr_b16 v[44:45], v5 offset:4096
    ds_read_b64_tr_b16 v[46:47], v5 offset:5120
    s_add_u32 m0, s69, 16384
    s_add_u32 s74, s26, 0
    buffer_load_dwordx4 v4, s[28:31], s74 offen lds
    v_mov_b32 v31, 0x3f80
    v_lshlrev_b32 v30, v30, v31
    v_mfma_f32_32x32x16_bf16 v[112:127], v[36:39], v[52:55], v[112:127]
    v_cndmask_b32_e64 v30, 0, v30, s[78:79]
    v_lshrrev_b32 v31, 1, v24
    s_waitcnt lgkmcnt(3)
    v_mfma_f32_32x32x16_bf16 v[64:79], v[40:43], v[56:59], v[64:79]
    ds_read_b64_tr_b16 v[32:33], v3 offset:8192
    ds_read_b64_tr_b16 v[34:35], v3 offset:9216
    s_add_u32 m0, s69, 32768
    s_add_u32 s74, s26, 114688
    buffer_load_dwordx4 v4, s[28:31], s74 offen lds
    v_cmp_eq_u32 vcc, 0, v31
    s_nop 1
    v_cndmask_b32_e64 v180, 0, v30, vcc
    v_cmp_eq_u32 vcc, 1, v31
    s_waitcnt lgkmcnt(4)
    v_mfma_f32_32x32x16_bf16 v[80:95], v[40:43], v[60:63], v[80:95]
    ds_read_b128 v[48:51], v8 offset:16384
    ds_read_b128 v[52:55], v8 offset:20480
    s_waitcnt lgkmcnt(4)
    v_mfma_f32_32x32x16_bf16 v[96:111], v[44:47], v[56:59], v[96:111]
    ds_read_b64_tr_b16 v[36:37], v5 offset:8192
    ds_read_b64_tr_b16 v[38:39], v5 offset:9216
    s_add_u32 m0, s69, 8192
    s_add_u32 s74, s25, 86016
    buffer_load_dwordx4 v2, s[32:35], s74 offen lds
    v_cndmask_b32_e64 v181, 0, v30, vcc
    v_cmp_eq_u32 vcc, 2, v31
    v_mfma_f32_32x32x16_bf16 v[112:127], v[44:47], v[60:63], v[112:127]
    s_add_u32 m0, s69, 24576
    s_add_u32 s74, s26, 57344
    buffer_load_dwordx4 v4, s[28:31], s74 offen lds
    v_cndmask_b32_e64 v182, 0, v30, vcc
    v_cmp_eq_u32 vcc, 3, v31
    s_nop 1
    v_cndmask_b32_e64 v183, 0, v30, vcc
    s_lshl_b32 s64, s66, 12
    s_waitcnt lgkmcnt(3)
    v_mfma_f32_32x32x16_bf16 v[64:79], v[32:35], v[48:51], v[64:79]
    ds_read_b64_tr_b16 v[40:41], v3 offset:12288
    ds_read_b64_tr_b16 v[42:43], v3 offset:13312
    s_add_u32 s64, s64, 49152
    v_add_u32 v20, s64, v1
    s_waitcnt lgkmcnt(4)
    v_mfma_f32_32x32x16_bf16 v[80:95], v[32:35], v[52:55], v[80:95]
    ds_read_b128 v[56:59], v9 offset:16384
    ds_read_b128 v[60:63], v9 offset:20480
    s_add_u32 m0, s69, 40960
    s_add_u32 s74, s26, 172032
    buffer_load_dwordx4 v4, s[28:31], s74 offen lds
    s_lshl_b32 s64, s18, 13
    s_add_u32 s64, s64, 49152
    s_waitcnt lgkmcnt(4)
    v_mfma_f32_32x32x16_bf16 v[96:111], v[36:39], v[48:51], v[96:111]
    ds_read_b64_tr_b16 v[44:45], v5 offset:12288
    ds_read_b64_tr_b16 v[46:47], v5 offset:13312
    v_and_b32 v28, 31, v0
    v_subrev_u32 v29, 2, v0
    v_mfma_f32_32x32x16_bf16 v[112:127], v[36:39], v[52:55], v[112:127]
    v_cmp_gt_u32 vcc, 28, v28
    s_nop 1
    v_cndmask_b32 v29, v29, v0, vcc
    s_waitcnt vmcnt(6) lgkmcnt(0)
    s_barrier
    v_add_u32 v3, v15, v3
    v_add_u32 v5, v15, v5
    v_add_u32 v6, 0xffff4000, v6
    v_add_u32 v7, 0xffff4000, v7
    v_add_u32 v8, 0xffff4000, v8
    v_add_u32 v9, 0xffff4000, v9
    v_mfma_f32_32x32x16_bf16 v[64:79], v[40:43], v[56:59], v[64:79]
    ds_read_b64_tr_b16 v[32:33], v3 offset:0
    ds_read_b64_tr_b16 v[34:35], v3 offset:1024
    v_and_b32 v28, 26, v0
    v_cmp_eq_u32 vcc, 26, v28
    v_and_b32 v28, 33, v0
    v_mfma_f32_32x32x16_bf16 v[80:95], v[40:43], v[60:63], v[80:95]
    ds_read_b128 v[48:51], v6 offset:16384
    ds_read_b128 v[52:55], v6 offset:20480
    v_mfma_f32_32x32x16_bf16 v[96:111], v[44:47], v[56:59], v[96:111]
    ds_read_b64_tr_b16 v[36:37], v5 offset:0
    ds_read_b64_tr_b16 v[38:39], v5 offset:1024
    s_add_u32 s24, s24, 1
    s_cmp_eq_u32 s24, 7
    s_cselect_b32 s24, 0, s24
    s_mul_i32 s25, s24, 172032
    s_add_u32 s25, s25, s67
    s_lshl_b32 s26, s24, 7
    s_add_u32 s26, s26, s68
    v_or_b32 v28, 28, v28
    v_cndmask_b32 v29, v29, v28, vcc
    v_mfma_f32_32x32x16_bf16 v[112:127], v[44:47], v[60:63], v[112:127]
    v_lshl_add_u32 v21, v29, 4, s64
    s_lshl_b32 s63, s72, 2
    s_add_u32 s63, s63, s19
    s_lshl_b32 s64, s63, 16
    s_waitcnt lgkmcnt(3)
    v_mfma_f32_32x32x16_bf16 v[64:79], v[32:35], v[48:51], v[64:79]
    ds_read_b64_tr_b16 v[40:41], v3 offset:4096
    ds_read_b64_tr_b16 v[42:43], v3 offset:5120
    s_lshl_b32 s65, s22, 11
    s_add_u32 s64, s64, s65
    s_waitcnt lgkmcnt(4)
    v_mfma_f32_32x32x16_bf16 v[80:95], v[32:35], v[52:55], v[80:95]
    ds_read_b128 v[56:59], v7 offset:16384
    ds_read_b128 v[60:63], v7 offset:20480
    s_add_u32 m0, s69, 98304
    s_add_u32 s74, s25, 0
    buffer_load_dwordx4 v2, s[32:35], s74 offen lds
    s_add_u32 s85, s64, 0x700000
    s_add_u32 s86, s85, 32768
    s_lshl_b32 s3, s63, 3
    s_waitcnt lgkmcnt(4)
    v_mfma_f32_32x32x16_bf16 v[96:111], v[36:39], v[48:51], v[96:111]
    ds_read_b64_tr_b16 v[44:45], v5 offset:4096
    ds_read_b64_tr_b16 v[46:47], v5 offset:5120
    s_add_u32 m0, s69, 114688
    s_add_u32 s74, s26, 0
    buffer_load_dwordx4 v4, s[28:31], s74 offen lds
    v_mfma_f32_32x32x16_bf16 v[112:127], v[36:39], v[52:55], v[112:127]
    s_add_u32 s3, s3, s73
    s_lshl_b32 s3, s3, 1
    s_add_u32 s3, s3, s18
    s_lshl_b32 s3, s3, 7
    s_waitcnt lgkmcnt(3)
    v_mfma_f32_32x32x16_bf16 v[64:79], v[40:43], v[56:59], v[64:79]
    ds_read_b64_tr_b16 v[32:33], v3 offset:8192
    ds_read_b64_tr_b16 v[34:35], v3 offset:9216
    s_add_u32 m0, s69, 131072
    s_add_u32 s74, s26, 114688
    buffer_load_dwordx4 v4, s[28:31], s74 offen lds
    s_add_u32 s3, s3, 0x9ac000
    s_lshl_b32 s87, s63, 8
    s_waitcnt lgkmcnt(4)
    v_mfma_f32_32x32x16_bf16 v[80:95], v[40:43], v[60:63], v[80:95]
    ds_read_b128 v[48:51], v8 offset:16384
    ds_read_b128 v[52:55], v8 offset:20480
    s_waitcnt lgkmcnt(4)
    v_mfma_f32_32x32x16_bf16 v[96:111], v[44:47], v[56:59], v[96:111]
    ds_read_b64_tr_b16 v[36:37], v5 offset:8192
    ds_read_b64_tr_b16 v[38:39], v5 offset:9216
    s_add_u32 m0, s69, 106496
    s_add_u32 s74, s25, 86016
    buffer_load_dwordx4 v2, s[32:35], s74 offen lds
    s_add_u32 s87, s87, 0x9c4000
    s_cmp_eq_u32 s22, 0
    s_cselect_b32 s87, s87, 0x4000000
    v_mfma_f32_32x32x16_bf16 v[112:127], v[44:47], v[60:63], v[112:127]
    s_add_u32 m0, s69, 122880
    s_add_u32 s74, s26, 57344
    buffer_load_dwordx4 v4, s[28:31], s74 offen lds
    v_cmp_eq_u32 vcc, 1, v0
    v_mov_b32 v28, 0x400
    s_nop 0
    v_cndmask_b32 v17, v17, v28, vcc
    v_mul_u32_u24 v22, 12, v0
    s_waitcnt lgkmcnt(3)
    v_mfma_f32_32x32x16_bf16 v[64:79], v[32:35], v[48:51], v[64:79]
    ds_read_b64_tr_b16 v[40:41], v3 offset:12288
    ds_read_b64_tr_b16 v[42:43], v3 offset:13312
    v_cmp_gt_u32 vcc, 16, v0
    v_mov_b32 v28, 0x4000000
    s_waitcnt lgkmcnt(4)
    v_mfma_f32_32x32x16_bf16 v[80:95], v[32:35], v[52:55], v[80:95]
    ds_read_b128 v[56:59], v9 offset:16384
    ds_read_b128 v[60:63], v9 offset:20480
    s_add_u32 m0, s69, 139264
    s_add_u32 s74, s26, 172032
    buffer_load_dwordx4 v4, s[28:31], s74 offen lds
    v_cndmask_b32 v23, v28, v23, vcc
    s_mul_i32 s63, s72, 1
    s_waitcnt lgkmcnt(4)
    v_mfma_f32_32x32x16_bf16 v[96:111], v[36:39], v[48:51], v[96:111]
    ds_read_b64_tr_b16 v[44:45], v5 offset:12288
    ds_read_b64_tr_b16 v[46:47], v5 offset:13312
    s_add_u32 s63, s63, 0
    s_and_b32 s63, s63, 3
    v_mfma_f32_32x32x16_bf16 v[112:127], v[36:39], v[52:55], v[112:127]
    s_lshl_b32 s63, s63, 10
    v_add_u32 v184, s63, v1
    s_waitcnt vmcnt(6) lgkmcnt(0)
    s_barrier
    v_add_u32 v3, v15, v3
    v_add_u32 v5, v15, v5
    v_add_u32 v6, 0xffff4000, v6
    v_add_u32 v7, 0xffff4000, v7
    v_add_u32 v8, 0xffff4000, v8
    v_add_u32 v9, 0xffff4000, v9
    v_mfma_f32_32x32x16_bf16 v[64:79], v[40:43], v[56:59], v[64:79]
    ds_read_b64_tr_b16 v[32:33], v3 offset:0
    ds_read_b64_tr_b16 v[34:35], v3 offset:1024
    v_add_u32 v185, s63, v22
    s_mul_i32 s63, s72, 1
    s_add_u32 s63, s63, 1
    v_mfma_f32_32x32x16_bf16 v[80:95], v[40:43], v[60:63], v[80:95]
    ds_read_b128 v[48:51], v6 offset:16384
    ds_read_b128 v[52:55], v6 offset:20480
    v_mfma_f32_32x32x16_bf16 v[96:111], v[44:47], v[56:59], v[96:111]
    ds_read_b64_tr_b16 v[36:37], v5 offset:0
    ds_read_b64_tr_b16 v[38:39], v5 offset:1024
    s_add_u32 s24, s24, 1
    s_cmp_eq_u32 s24, 7
    s_cselect_b32 s24, 0, s24
    s_mul_i32 s25, s24, 172032
    s_add_u32 s25, s25, s67
    s_lshl_b32 s26, s24, 7
    s_add_u32 s26, s26, s68
    s_and_b32 s63, s63, 3
    s_lshl_b32 s63, s63, 10
    v_mfma_f32_32x32x16_bf16 v[112:127], v[44:47], v[60:63], v[112:127]
    v_add_u32 v186, s63, v1
    v_add_u32 v187, s63, v22
    s_mul_i32 s63, s72, 1
    s_add_u32 s63, s63, 2
    s_waitcnt lgkmcnt(3)
    v_mfma_f32_32x32x16_bf16 v[64:79], v[32:35], v[48:51], v[64:79]
    ds_read_b64_tr_b16 v[40:41], v3 offset:4096
    ds_read_b64_tr_b16 v[42:43], v3 offset:5120
    s_and_b32 s63, s63, 3
    s_lshl_b32 s63, s63, 10
    s_waitcnt lgkmcnt(4)
    v_mfma_f32_32x32x16_bf16 v[80:95], v[32:35], v[52:55], v[80:95]
    ds_read_b128 v[56:59], v7 offset:16384
    ds_read_b128 v[60:63], v7 offset:20480
    s_add_u32 m0, s69, 49152
    s_add_u32 s74, s25, 0
    buffer_load_dwordx4 v2, s[32:35], s74 offen lds
    v_add_u32 v188, s63, v1
    v_add_u32 v189, s63, v22
    s_waitcnt lgkmcnt(4)
    v_mfma_f32_32x32x16_bf16 v[96:111], v[36:39], v[48:51], v[96:111]
    ds_read_b64_tr_b16 v[44:45], v5 offset:4096
    ds_read_b64_tr_b16 v[46:47], v5 offset:5120
    s_add_u32 m0, s69, 65536
    s_add_u32 s74, s26, 0
    buffer_load_dwordx4 v4, s[28:31], s74 offen lds
    s_mul_i32 s63, s72, 1
    s_add_u32 s63, s63, 3
    v_mfma_f32_32x32x16_bf16 v[112:127], v[36:39], v[52:55], v[112:127]
    s_and_b32 s63, s63, 3
    s_lshl_b32 s63, s63, 10
    s_waitcnt lgkmcnt(3)
    v_mfma_f32_32x32x16_bf16 v[64:79], v[40:43], v[56:59], v[64:79]
    ds_read_b64_tr_b16 v[32:33], v3 offset:8192
    ds_read_b64_tr_b16 v[34:35], v3 offset:9216
    s_add_u32 m0, s69, 81920
    s_add_u32 s74, s26, 114688
    buffer_load_dwordx4 v4, s[28:31], s74 offen lds
    v_add_u32 v190, s63, v1
    v_add_u32 v191, s63, v22
    s_mul_i32 s65, s18, 3136
    s_waitcnt lgkmcnt(4)
    v_mfma_f32_32x32x16_bf16 v[80:95], v[40:43], v[60:63], v[80:95]
    ds_read_b128 v[48:51], v8 offset:16384
    ds_read_b128 v[52:55], v8 offset:20480
    s_waitcnt lgkmcnt(4)
    v_mfma_f32_32x32x16_bf16 v[96:111], v[44:47], v[56:59], v[96:111]
    ds_read_b64_tr_b16 v[36:37], v5 offset:8192
    ds_read_b64_tr_b16 v[38:39], v5 offset:9216
    s_add_u32 m0, s69, 57344
    s_add_u32 s74, s25, 86016
    buffer_load_dwordx4 v2, s[32:35], s74 offen lds
    s_add_u32 s65, s65, 98304
    v_and_b32 v28, 31, v0
    v_mfma_f32_32x32x16_bf16 v[112:127], v[44:47], v[60:63], v[112:127]
    s_add_u32 m0, s69, 73728
    s_add_u32 s74, s26, 57344
    buffer_load_dwordx4 v4, s[28:31], s74 offen lds
    v_subrev_u32 v29, 2, v28
    v_cmp_gt_u32 vcc, 28, v28
    s_nop 1
    v_cndmask_b32 v29, v29, v28, vcc
    v_lshlrev_b32 v29, 1, v29
    s_waitcnt lgkmcnt(3)
    v_mfma_f32_32x32x16_bf16 v[64:79], v[32:35], v[48:51], v[64:79]
    ds_read_b64_tr_b16 v[40:41], v3 offset:12288
    ds_read_b64_tr_b16 v[42:43], v3 offset:13312
    v_lshrrev_b32 v25, 5, v0
    v_mul_u32_u24 v25, 224, v25
    s_waitcnt lgkmcnt(4)
    v_mfma_f32_32x32x16_bf16 v[80:95], v[32:35], v[52:55], v[80:95]
    ds_read_b128 v[56:59], v9 offset:16384
    ds_read_b128 v[60:63], v9 offset:20480
    s_add_u32 m0, s69, 90112
    s_add_u32 s74, s26, 172032
    buffer_load_dwordx4 v4, s[28:31], s74 offen lds
    v_add3_u32 v25, v25, v29, s65
    v_and_b32 v28, 26, v28
    s_waitcnt lgkmcnt(4)
    v_mfma_f32_32x32x16_bf16 v[96:111], v[36:39], v[48:51], v[96:111]
    ds_read_b64_tr_b16 v[44:45], v5 offset:12288
    ds_read_b64_tr_b16 v[46:47], v5 offset:13312
    v_cmp_eq_u32 vcc, 26, v28
    s_nop 1
    v_cndmask_b32_e64 v26, -1, 0, vcc
    v_mfma_f32_32x32x16_bf16 v[112:127], v[36:39], v[52:55], v[112:127]
    v_cmp_lt_u32 vcc, 31, v0
    s_nop 1
    v_cndmask_b32_e64 v27, v26, 0, vcc
    s_waitcnt vmcnt(6) lgkmcnt(0)
    s_barrier
    v_add_u32 v3, v14, v3
    v_add_u32 v5, v14, v5
    v_add_u32 v6, 0x18000, v6
    v_add_u32 v7, 0x18000, v7
    v_add_u32 v8, 0x18000, v8
    v_add_u32 v9, 0x18000, v9
    v_lshrrev_b32 v19, 3, v0
    v_lshlrev_b32 v19, 8, v19
    v_lshl_add_u32 v19, v0, 2, v19
    buffer_load_dword v16, v19, s[56:59], 0 offen sc1
    v_mfma_f32_32x32x16_bf16 v[64:79], v[40:43], v[56:59], v[64:79]
    ds_read_b64_tr_b16 v[32:33], v3 offset:0
    ds_read_b64_tr_b16 v[34:35], v3 offset:1024
    v_mfma_f32_32x32x16_bf16 v[80:95], v[40:43], v[60:63], v[80:95]
    ds_read_b128 v[48:51], v6 offset:16384
    ds_read_b128 v[52:55], v6 offset:20480
    v_mfma_f32_32x32x16_bf16 v[96:111], v[44:47], v[56:59], v[96:111]
    ds_read_b64_tr_b16 v[36:37], v5 offset:0
    ds_read_b64_tr_b16 v[38:39], v5 offset:1024
    s_add_u32 s24, s24, 1
    s_cmp_eq_u32 s24, 7
    s_cselect_b32 s24, 0, s24
    s_mul_i32 s25, s24, 172032
    s_add_u32 s25, s25, s67
    s_lshl_b32 s26, s24, 7
    s_add_u32 s26, s26, s68
    v_mfma_f32_32x32x16_bf16 v[112:127], v[44:47], v[60:63], v[112:127]
    s_waitcnt lgkmcnt(3)
    v_mfma_f32_32x32x16_bf16 v[64:79], v[32:35], v[48:51], v[64:79]
    ds_read_b64_tr_b16 v[40:41], v3 offset:4096
    ds_read_b64_tr_b16 v[42:43], v3 offset:5120
    s_waitcnt lgkmcnt(4)
    v_mfma_f32_32x32x16_bf16 v[80:95], v[32:35], v[52:55], v[80:95]
    ds_read_b128 v[56:59], v7 offset:16384
    ds_read_b128 v[60:63], v7 offset:20480
    s_add_u32 m0, s69, 0
    s_add_u32 s74, s25, 0
    buffer_load_dwordx4 v2, s[32:35], s74 offen lds
    s_waitcnt lgkmcnt(4)
    v_mfma_f32_32x32x16_bf16 v[96:111], v[36:39], v[48:51], v[96:111]
    ds_read_b64_tr_b16 v[44:45], v5 offset:4096
    ds_read_b64_tr_b16 v[46:47], v5 offset:5120
    s_add_u32 m0, s69, 16384
    s_add_u32 s74, s26, 0
    buffer_load_dwordx4 v4, s[28:31], s74 offen lds
    v_mfma_f32_32x32x16_bf16 v[112:127], v[36:39], v[52:55], v[112:127]
    s_waitcnt lgkmcnt(3)
    v_mfma_f32_32x32x16_bf16 v[64:79], v[40:43], v[56:59], v[64:79]
    ds_read_b64_tr_b16 v[32:33], v3 offset:8192
    ds_read_b64_tr_b16 v[34:35], v3 offset:9216
    s_add_u32 m0, s69, 32768
    s_add_u32 s74, s26, 114688
    buffer_load_dwordx4 v4, s[28:31], s74 offen lds
    s_waitcnt lgkmcnt(4)
    v_mfma_f32_32x32x16_bf16 v[80:95], v[40:43], v[60:63], v[80:95]
    ds_read_b128 v[48:51], v8 offset:16384
    ds_read_b128 v[52:55], v8 offset:20480
    s_waitcnt lgkmcnt(4)
    v_mfma_f32_32x32x16_bf16 v[96:111], v[44:47], v[56:59], v[96:111]
    ds_read_b64_tr_b16 v[36:37], v5 offset:8192
    ds_read_b64_tr_b16 v[38:39], v5 offset:9216
    s_add_u32 m0, s69, 8192
    s_add_u32 s74, s25, 86016
    buffer_load_dwordx4 v2, s[32:35], s74 offen lds
    v_mfma_f32_32x32x16_bf16 v[112:127], v[44:47], v[60:63], v[112:127]
    s_add_u32 m0, s69, 24576
    s_add_u32 s74, s26, 57344
    buffer_load_dwordx4 v4, s[28:31], s74 offen lds
    s_waitcnt lgkmcnt(3)
    v_mfma_f32_32x32x16_bf16 v[64:79], v[32:35], v[48:51], v[64:79]
    ds_read_b64_tr_b16 v[40:41], v3 offset:12288
    ds_read_b64_tr_b16 v[42:43], v3 offset:13312
    s_waitcnt lgkmcnt(4)
    v_mfma_f32_32x32x16_bf16 v[80:95], v[32:35], v[52:55], v[80:95]
    ds_read_b128 v[56:59], v9 offset:16384
    ds_read_b128 v[60:63], v9 offset:20480
    s_add_u32 m0, s69, 40960
    s_add_u32 s74, s26, 172032
    buffer_load_dwordx4 v4, s[28:31], s74 offen lds
    s_waitcnt lgkmcnt(4)
    v_mfma_f32_32x32x16_bf16 v[96:111], v[36:39], v[48:51], v[96:111]
    ds_read_b64_tr_b16 v[44:45], v5 offset:12288
    ds_read_b64_tr_b16 v[46:47], v5 offset:13312
    v_mfma_f32_32x32x16_bf16 v[112:127], v[36:39], v[52:55], v[112:127]
    s_waitcnt vmcnt(7) lgkmcnt(0)
    s_barrier
    v_add_u32 v3, v15, v3
    v_add_u32 v5, v15, v5
    v_add_u32 v6, 0xffff4000, v6
    v_add_u32 v7, 0xffff4000, v7
    v_add_u32 v8, 0xffff4000, v8
    v_add_u32 v9, 0xffff4000, v9
    v_mfma_f32_32x32x16_bf16 v[64:79], v[40:43], v[56:59], v[64:79]
    ds_read_b64_tr_b16 v[32:33], v3 offset:0
    ds_read_b64_tr_b16 v[34:35], v3 offset:1024
    v_mfma_f32_32x32x16_bf16 v[80:95], v[40:43], v[60:63], v[80:95]
    ds_read_b128 v[48:51], v6 offset:16384
    ds_read_b128 v[52:55], v6 offset:20480
    v_mfma_f32_32x32x16_bf16 v[96:111], v[44:47], v[56:59], v[96:111]
    ds_read_b64_tr_b16 v[36:37], v5 offset:0
    ds_read_b64_tr_b16 v[38:39], v5 offset:1024
    v_mfma_f32_32x32x16_bf16 v[112:127], v[44:47], v[60:63], v[112:127]
    s_waitcnt lgkmcnt(3)
    v_mfma_f32_32x32x16_bf16 v[64:79], v[32:35], v[48:51], v[64:79]
    ds_read_b64_tr_b16 v[40:41], v3 offset:4096
    ds_read_b64_tr_b16 v[42:43], v3 offset:5120
    s_waitcnt lgkmcnt(4)
    v_mfma_f32_32x32x16_bf16 v[80:95], v[32:35], v[52:55], v[80:95]
    ds_read_b128 v[56:59], v7 offset:16384
    ds_read_b128 v[60:63], v7 offset:20480
    s_waitcnt lgkmcnt(4)
    v_mfma_f32_32x32x16_bf16 v[96:111], v[36:39], v[48:51], v[96:111]
    ds_read_b64_tr_b16 v[44:45], v5 offset:4096
    ds_read_b64_tr_b16 v[46:47], v5 offset:5120
    v_mfma_f32_32x32x16_bf16 v[112:127], v[36:39], v[52:55], v[112:127]
    s_add_u32 m0, s69, 98304
    s_add_u32 s74, s71, 0
    buffer_load_dwordx4 v1, s[36:39], s74 offen lds
    s_waitcnt lgkmcnt(3)
    v_mfma_f32_32x32x16_bf16 v[64:79], v[40:43], v[56:59], v[64:79]
    ds_read_b64_tr_b16 v[32:33], v3 offset:8192
    ds_read_b64_tr_b16 v[34:35], v3 offset:9216
    s_waitcnt lgkmcnt(4)
    v_mfma_f32_32x32x16_bf16 v[80:95], v[40:43], v[60:63], v[80:95]
    ds_read_b128 v[48:51], v8 offset:16384
    ds_read_b128 v[52:55], v8 offset:20480
    s_waitcnt lgkmcnt(4)
    v_mfma_f32_32x32x16_bf16 v[96:111], v[44:47], v[56:59], v[96:111]
    ds_read_b64_tr_b16 v[36:37], v5 offset:8192
    ds_read_b64_tr_b16 v[38:39], v5 offset:9216
    v_mfma_f32_32x32x16_bf16 v[112:127], v[44:47], v[60:63], v[112:127]
    s_waitcnt lgkmcnt(3)
    v_mfma_f32_32x32x16_bf16 v[64:79], v[32:35], v[48:51], v[64:79]
    ds_read_b64_tr_b16 v[40:41], v3 offset:12288
    ds_read_b64_tr_b16 v[42:43], v3 offset:13312
    s_waitcnt lgkmcnt(4)
    v_mfma_f32_32x32x16_bf16 v[80:95], v[32:35], v[52:55], v[80:95]
    ds_read_b128 v[56:59], v9 offset:16384
    ds_read_b128 v[60:63], v9 offset:20480
    s_waitcnt lgkmcnt(4)
    v_mfma_f32_32x32x16_bf16 v[96:111], v[36:39], v[48:51], v[96:111]
    ds_read_b64_tr_b16 v[44:45], v5 offset:12288
    ds_read_b64_tr_b16 v[46:47], v5 offset:13312
    v_mfma_f32_32x32x16_bf16 v[112:127], v[36:39], v[52:55], v[112:127]
    s_waitcnt vmcnt(0) lgkmcnt(0)
    s_barrier
    v_add_u32 v3, v15, v3
    v_add_u32 v5, v15, v5
    v_add_u32 v6, 0xffff4000, v6
    v_add_u32 v7, 0xffff4000, v7
    v_add_u32 v8, 0xffff4000, v8
    v_add_u32 v9, 0xffff4000, v9
    v_cmp_eq_u32 vcc, 0, v16
    s_nop 1
    s_and_b32 s74, vcc_lo, 63
    s_cbranch_scc0 L_ok8
    s_mov_b32 s75, 40000
L_sp8:
    s_sleep 2
    buffer_load_dword v16, v19, s[56:59], 0 offen sc1
    s_waitcnt vmcnt(0)
    v_cmp_eq_u32 vcc, 0, v16
    s_sub_u32 s75, s75, 1
    s_cmp_eq_u32 s75, 0
    s_cbranch_scc1 L_ok8
    s_and_b32 s74, vcc_lo, 63
    s_cbranch_scc1 L_sp8
L_ok8:
    v_mfma_f32_32x32x16_bf16 v[64:79], v[40:43], v[56:59], v[64:79]
    ds_read_b64_tr_b16 v[32:33], v3 offset:0
    ds_read_b64_tr_b16 v[34:35], v3 offset:1024
    ds_read_u16 v144, v25 offset:0
    ds_read_u16 v145, v25 offset:56
    v_mfma_f32_32x32x16_bf16 v[80:95], v[40:43], v[60:63], v[80:95]
    ds_read_b128 v[48:51], v6 offset:16384
    ds_read_b128 v[52:55], v6 offset:20480
    ds_read_u16 v146, v25 offset:112
    ds_read_u16 v147, v25 offset:168
    v_mfma_f32_32x32x16_bf16 v[96:111], v[44:47], v[56:59], v[96:111]
    ds_read_b64_tr_b16 v[36:37], v5 offset:0
    ds_read_b64_tr_b16 v[38:39], v5 offset:1024
    ds_read_u16 v148, v25 offset:448
    ds_read_u16 v149, v25 offset:504
    v_mfma_f32_32x32x16_bf16 v[112:127], v[44:47], v[60:63], v[112:127]
    ds_read_u16 v150, v25 offset:560
    ds_read_u16 v151, v25 offset:616
    s_waitcnt lgkmcnt(9)
    v_mfma_f32_32x32x16_bf16 v[64:79], v[32:35], v[48:51], v[64:79]
    ds_read_b64_tr_b16 v[40:41], v3 offset:4096
    ds_read_b64_tr_b16 v[42:43], v3 offset:5120
    ds_read_u16 v152, v25 offset:896
    ds_read_u16 v153, v25 offset:952
    s_waitcnt lgkmcnt(12)
    v_mfma_f32_32x32x16_bf16 v[80:95], v[32:35], v[52:55], v[80:95]
    ds_read_b128 v[56:59], v7 offset:16384
    ds_read_b128 v[60:63], v7 offset:20480
    ds_read_u16 v154, v25 offset:1008
    ds_read_u16 v155, v25 offset:1064
    s_waitcnt lgkmcnt(12)
    v_mfma_f32_32x32x16_bf16 v[96:111], v[36:39], v[48:51], v[96:111]
    ds_read_b64_tr_b16 v[44:45], v5 offset:4096
    ds_read_b64_tr_b16 v[46:47], v5 offset:5120
    ds_read_u16 v156, v25 offset:1344
    ds_read_u16 v157, v25 offset:1400
    v_mfma_f32_32x32x16_bf16 v[112:127], v[36:39], v[52:55], v[112:127]
    ds_read_u16 v158, v25 offset:1456
    ds_read_u16 v159, v25 offset:1512
    s_waitcnt lgkmcnt(9)
    v_mfma_f32_32x32x16_bf16 v[64:79], v[40:43], v[56:59], v[64:79]
    ds_read_b64_tr_b16 v[32:33], v3 offset:8192
    ds_read_b64_tr_b16 v[34:35], v3 offset:9216
    ds_read_u16 v240, v25 offset:1568
    ds_read_u16 v241, v25 offset:1624
    s_waitcnt lgkmcnt(12)
    v_mfma_f32_32x32x16_bf16 v[80:95], v[40:43], v[60:63], v[80:95]
    ds_read_b128 v[48:51], v8 offset:16384
    ds_read_b128 v[52:55], v8 offset:20480
    ds_read_u16 v242, v25 offset:1680
    ds_read_u16 v243, v25 offset:1736
    s_waitcnt lgkmcnt(12)
    v_mfma_f32_32x32x16_bf16 v[96:111], v[44:47], v[56:59], v[96:111]
    ds_read_b64_tr_b16 v[36:37], v5 offset:8192
    ds_read_b64_tr_b16 v[38:39], v5 offset:9216
    ds_read_u16 v244, v25 offset:2016
    ds_read_u16 v245, v25 offset:2072
    v_mfma_f32_32x32x16_bf16 v[112:127], v[44:47], v[60:63], v[112:127]
    ds_read_u16 v246, v25 offset:2128
    ds_read_u16 v247, v25 offset:2184
    s_waitcnt lgkmcnt(9)
    v_mfma_f32_32x32x16_bf16 v[64:79], v[32:35], v[48:51], v[64:79]
    ds_read_b64_tr_b16 v[40:41], v3 offset:12288
    ds_read_b64_tr_b16 v[42:43], v3 offset:13312
    ds_read_u16 v248, v25 offset:2464
    ds_read_u16 v249, v25 offset:2520
    s_waitcnt lgkmcnt(12)
    v_mfma_f32_32x32x16_bf16 v[80:95], v[32:35], v[52:55], v[80:95]
    ds_read_b128 v[56:59], v9 offset:16384
    ds_read_b128 v[60:63], v9 offset:20480
    ds_read_u16 v250, v25 offset:2576
    ds_read_u16 v251, v25 offset:2632
    s_waitcnt lgkmcnt(12)
    v_mfma_f32_32x32x16_bf16 v[96:111], v[36:39], v[48:51], v[96:111]
    ds_read_b64_tr_b16 v[44:45], v5 offset:12288
    ds_read_b64_tr_b16 v[46:47], v5 offset:13312
    ds_read_u16 v252, v25 offset:2912
    ds_read_u16 v253, v25 offset:2968
    v_mfma_f32_32x32x16_bf16 v[112:127], v[36:39], v[52:55], v[112:127]
    ds_read_u16 v254, v25 offset:3024
    ds_read_u16 v255, v25 offset:3080
    s_waitcnt lgkmcnt(9)
    v_mfma_f32_32x32x16_bf16 v[64:79], v[40:43], v[56:59], v[64:79]
    v_lshl_or_b32 v128, v145, 16, v144
    v_and_b32 v128, v128, v26
    v_lshl_or_b32 v129, v147, 16, v146
    v_and_b32 v129, v129, v26
    s_waitcnt lgkmcnt(8)
    v_mfma_f32_32x32x16_bf16 v[80:95], v[40:43], v[60:63], v[80:95]
    v_lshl_or_b32 v130, v149, 16, v148
    v_and_b32 v130, v130, v26
    v_lshl_or_b32 v131, v151, 16, v150
    v_and_b32 v131, v131, v26
    s_waitcnt lgkmcnt(4)
    v_mfma_f32_32x32x16_bf16 v[96:111], v[44:47], v[56:59], v[96:111]
    v_lshl_or_b32 v132, v153, 16, v152
    v_and_b32 v132, v132, v26
    v_lshl_or_b32 v133, v155, 16, v154
    v_and_b32 v133, v133, v26
    v_mfma_f32_32x32x16_bf16 v[112:127], v[44:47], v[60:63], v[112:127]
    v_lshl_or_b32 v134, v157, 16, v156
    v_and_b32 v134, v134, v27
    v_lshl_or_b32 v135, v159, 16, v158
    v_and_b32 v135, v135, v27
    s_cmp_ge_u32 s60, 4
    s_cbranch_scc1 L_q_trail
    s_setprio 2
L_q_trail:
    v_cvt_pk_bf16_f32 v64, v64, v65
    v_cvt_pk_bf16_f32 v65, v66, v67
    v_cvt_pk_bf16_f32 v66, v68, v69
    v_cvt_pk_bf16_f32 v67, v70, v71
    v_cvt_pk_bf16_f32 v68, v72, v73
    v_cvt_pk_bf16_f32 v69, v74, v75
    v_cvt_pk_bf16_f32 v70, v76, v77
    v_cvt_pk_bf16_f32 v71, v78, v79
    v_mfma_f32_32x32x16_bf16 v[144:159], v[128:131], v[64:67], 0
    s_nop 0
    v_mfma_f32_32x32x16_bf16 v[144:159], v[132:135], v[68:71], v[144:159]
    v_cvt_pk_bf16_f32 v80, v80, v81
    v_cvt_pk_bf16_f32 v81, v82, v83
    v_cvt_pk_bf16_f32 v82, v84, v85
    v_cvt_pk_bf16_f32 v83, v86, v87
    v_cvt_pk_bf16_f32 v84, v88, v89
    v_cvt_pk_bf16_f32 v85, v90, v91
    v_cvt_pk_bf16_f32 v86, v92, v93
    v_cvt_pk_bf16_f32 v87, v94, v95
    v_mfma_f32_32x32x16_bf16 v[160:175], v[128:131], v[80:83], 0
    s_nop 0
    v_mfma_f32_32x32x16_bf16 v[160:175], v[132:135], v[84:87], v[160:175]
    v_mul_f32_e64 v2, -s70, v76
    v_mul_f32_e64 v3, -s70, v92
    v_exp_f32 v2, v2
    v_exp_f32 v3, v3
    v_add_f32 v2, 1.0, v2
    v_add_f32 v3, 1.0, v3
    v_rcp_f32 v2, v2
    v_rcp_f32 v3, v3
    v_mov_b32 v4, v2
    v_mov_b32 v5, v3
    s_nop 0
    v_permlane32_swap_b32 v4, v2
    v_permlane32_swap_b32 v5, v3
    v_sub_f32 v4, 1.0, v2
    v_sub_f32 v5, 1.0, v3
    v_lshlrev_b32 v6, 2, v0
    v_lshl_or_b32 v136, v241, 16, v240
    v_and_b32 v136, v136, v26
    v_lshl_or_b32 v137, v243, 16, v242
    v_and_b32 v137, v137, v26
    v_lshl_or_b32 v138, v245, 16, v244
    v_and_b32 v138, v138, v26
    v_lshl_or_b32 v139, v247, 16, v246
    v_and_b32 v139, v139, v26
    v_lshl_or_b32 v140, v249, 16, v248
    v_and_b32 v140, v140, v26
    v_lshl_or_b32 v141, v251, 16, v250
    v_and_b32 v141, v141, v26
    s_waitcnt lgkmcnt(2)
    v_lshl_or_b32 v142, v253, 16, v252
    v_and_b32 v142, v142, v27
    s_waitcnt lgkmcnt(0)
    v_lshl_or_b32 v143, v255, 16, v254
    v_and_b32 v143, v143, v27
    v_permlane32_swap_b32 v4, v5
    v_or_b32 v4, 0x80000000, v4
    s_cmp_eq_u32 s22, 0
    s_cbranch_scc0 L_no9
    buffer_store_dword v4, v6, s[40:43], s87 offen sc1
L_no9:
    v_max3_f32 v48, v144, v145, v146
    v_max3_f32 v50, -v144, -v145, -v146
    v_max3_f32 v48, v48, v147, v148
    v_max3_f32 v50, v50, -v147, -v148
    v_max3_f32 v48, v48, v149, v150
    v_max3_f32 v50, v50, -v149, -v150
    v_max3_f32 v48, v48, v151, v152
    v_max3_f32 v50, v50, -v151, -v152
    v_max3_f32 v48, v48, v153, v154
    v_max3_f32 v50, v50, -v153, -v154
    v_max3_f32 v48, v48, v155, v156
    v_max3_f32 v50, v50, -v155, -v156
    v_max_f32 v48, v48, v157
    v_max_f32_e64 v50, v50, -v157
    v_max3_f32 v52, v160, v161, v162
    v_max3_f32 v54, -v160, -v161, -v162
    v_max3_f32 v52, v52, v163, v164
    v_max3_f32 v54, v54, -v163, -v164
    v_max3_f32 v52, v52, v165, v166
    v_max3_f32 v54, v54, -v165, -v166
    v_max3_f32 v52, v52, v167, v168
    v_max3_f32 v54, v54, -v167, -v168
    v_max3_f32 v52, v52, v169, v170
    v_max3_f32 v54, v54, -v169, -v170
    v_max3_f32 v52, v52, v171, v172
    v_max3_f32 v54, v54, -v171, -v172
    v_max_f32 v52, v52, v173
    v_max_f32_e64 v54, v54, -v173
    v_permlane32_swap_b32 v48, v50
    s_nop 0
    v_permlane32_swap_b32 v52, v54
    v_max_f32 v48, v48, v50
    v_max_f32 v52, v52, v54
    v_mul_f32_e64 v48, -s70, v48
    v_mul_f32_e64 v52, -s70, v52
    v_mov_b32 v50, v48
    v_mov_b32 v54, v52
    s_nop 0
    v_permlane32_swap_b32 v48, v50
    v_permlane32_swap_b32 v52, v54
    v_pk_fma_f32 v[64:65], v[144:145], s[70:71], v[48:49] op_sel_hi:[1,0,0]
    v_pk_fma_f32 v[144:145], v[144:145], s[70:71], v[50:51] op_sel_hi:[1,0,0] neg_lo:[1,0,0] neg_hi:[1,0,0]
    v_pk_fma_f32 v[66:67], v[146:147], s[70:71], v[48:49] op_sel_hi:[1,0,0]
    v_pk_fma_f32 v[146:147], v[146:147], s[70:71], v[50:51] op_sel_hi:[1,0,0] neg_lo:[1,0,0] neg_hi:[1,0,0]
    v_pk_fma_f32 v[68:69], v[148:149], s[70:71], v[48:49] op_sel_hi:[1,0,0]
    v_pk_fma_f32 v[148:149], v[148:149], s[70:71], v[50:51] op_sel_hi:[1,0,0] neg_lo:[1,0,0] neg_hi:[1,0,0]
    v_pk_fma_f32 v[70:71], v[150:151], s[70:71], v[48:49] op_sel_hi:[1,0,0]
    v_pk_fma_f32 v[150:151], v[150:151], s[70:71], v[50:51] op_sel_hi:[1,0,0] neg_lo:[1,0,0] neg_hi:[1,0,0]
    v_pk_fma_f32 v[72:73], v[152:153], s[70:71], v[48:49] op_sel_hi:[1,0,0]
    v_pk_fma_f32 v[152:153], v[152:153], s[70:71], v[50:51] op_sel_hi:[1,0,0] neg_lo:[1,0,0] neg_hi:[1,0,0]
    v_pk_fma_f32 v[74:75], v[154:155], s[70:71], v[48:49] op_sel_hi:[1,0,0]
    v_pk_fma_f32 v[154:155], v[154:155], s[70:71], v[50:51] op_sel_hi:[1,0,0] neg_lo:[1,0,0] neg_hi:[1,0,0]
    v_pk_fma_f32 v[76:77], v[156:157], s[70:71], v[48:49] op_sel_hi:[1,0,0]
    v_pk_fma_f32 v[156:157], v[156:157], s[70:71], v[50:51] op_sel_hi:[1,0,0] neg_lo:[1,0,0] neg_hi:[1,0,0]
    v_pk_fma_f32 v[80:81], v[160:161], s[70:71], v[52:53] op_sel_hi:[1,0,0]
    v_pk_fma_f32 v[160:161], v[160:161], s[70:71], v[54:55] op_sel_hi:[1,0,0] neg_lo:[1,0,0] neg_hi:[1,0,0]
    v_pk_fma_f32 v[82:83], v[162:163], s[70:71], v[52:53] op_sel_hi:[1,0,0]
    v_pk_fma_f32 v[162:163], v[162:163], s[70:71], v[54:55] op_sel_hi:[1,0,0] neg_lo:[1,0,0] neg_hi:[1,0,0]
    v_pk_fma_f32 v[84:85], v[164:165], s[70:71], v[52:53] op_sel_hi:[1,0,0]
    v_pk_fma_f32 v[164:165], v[164:165], s[70:71], v[54:55] op_sel_hi:[1,0,0] neg_lo:[1,0,0] neg_hi:[1,0,0]
    v_pk_fma_f32 v[86:87], v[166:167], s[70:71], v[52:53] op_sel_hi:[1,0,0]
    v_pk_fma_f32 v[166:167], v[166:167], s[70:71], v[54:55] op_sel_hi:[1,0,0] neg_lo:[1,0,0] neg_hi:[1,0,0]
    v_pk_fma_f32 v[88:89], v[168:169], s[70:71], v[52:53] op_sel_hi:[1,0,0]
    v_pk_fma_f32 v[168:169], v[168:169], s[70:71], v[54:55] op_sel_hi:[1,0,0] neg_lo:[1,0,0] neg_hi:[1,0,0]
    v_pk_fma_f32 v[90:91], v[170:171], s[70:71], v[52:53] op_sel_hi:[1,0,0]
    v_pk_fma_f32 v[170:171], v[170:171], s[70:71], v[54:55] op_sel_hi:[1,0,0] neg_lo:[1,0,0] neg_hi:[1,0,0]
    v_pk_fma_f32 v[92:93], v[172:173], s[70:71], v[52:53] op_sel_hi:[1,0,0]
    v_pk_fma_f32 v[172:173], v[172:173], s[70:71], v[54:55] op_sel_hi:[1,0,0] neg_lo:[1,0,0] neg_hi:[1,0,0]
    v_exp_f32 v64, v64
    v_exp_f32 v144, v144
    v_exp_f32 v65, v65
    v_exp_f32 v145, v145
    v_exp_f32 v66, v66
    v_exp_f32 v146, v146
    v_exp_f32 v67, v67
    v_exp_f32 v147, v147
    v_exp_f32 v68, v68
    v_exp_f32 v148, v148
    v_exp_f32 v69, v69
    v_exp_f32 v149, v149
    v_exp_f32 v70, v70
    v_exp_f32 v150, v150
    v_exp_f32 v71, v71
    v_exp_f32 v151, v151
    v_exp_f32 v72, v72
    v_exp_f32 v152, v152
    v_exp_f32 v73, v73
    v_exp_f32 v153, v153
    v_exp_f32 v74, v74
    v_exp_f32 v154, v154
    v_exp_f32 v75, v75
    v_exp_f32 v155, v155
    v_exp_f32 v76, v76
    v_exp_f32 v156, v156
    v_exp_f32 v77, v77
    v_exp_f32 v157, v157
    v_exp_f32 v80, v80
    v_exp_f32 v160, v160
    v_exp_f32 v81, v81
    v_exp_f32 v161, v161
    v_exp_f32 v82, v82
    v_exp_f32 v162, v162
    v_exp_f32 v83, v83
    v_exp_f32 v163, v163
    v_exp_f32 v84, v84
    v_exp_f32 v164, v164
    v_exp_f32 v85, v85
    v_exp_f32 v165, v165
    v_exp_f32 v86, v86
    v_exp_f32 v166, v166
    v_exp_f32 v87, v87
    v_exp_f32 v167, v167
    v_exp_f32 v88, v88
    v_exp_f32 v168, v168
    v_exp_f32 v89, v89
    v_exp_f32 v169, v169
    v_exp_f32 v90, v90
    v_exp_f32 v170, v170
    v_exp_f32 v91, v91
    v_exp_f32 v171, v171
    v_exp_f32 v92, v92
    v_exp_f32 v172, v172
    v_exp_f32 v93, v93
    v_exp_f32 v173, v173
    v_pk_add_f32 v[56:57], v[64:65], v[66:67]
    v_pk_add_f32 v[58:59], v[144:145], v[146:147]
    v_pk_add_f32 v[60:61], v[80:81], v[82:83]
    v_pk_add_f32 v[62:63], v[160:161], v[162:163]
    v_pk_add_f32 v[56:57], v[56:57], v[68:69]
    v_pk_add_f32 v[58:59], v[58:59], v[148:149]
    v_pk_add_f32 v[60:61], v[60:61], v[84:85]
    v_pk_add_f32 v[62:63], v[62:63], v[164:165]
    v_pk_add_f32 v[56:57], v[56:57], v[70:71]
    v_pk_add_f32 v[58:59], v[58:59], v[150:151]
    v_pk_add_f32 v[60:61], v[60:61], v[86:87]
    v_pk_add_f32 v[62:63], v[62:63], v[166:167]
    v_pk_add_f32 v[56:57], v[56:57], v[72:73]
    v_pk_add_f32 v[58:59], v[58:59], v[152:153]
    v_pk_add_f32 v[60:61], v[60:61], v[88:89]
    v_pk_add_f32 v[62:63], v[62:63], v[168:169]
    v_pk_add_f32 v[56:57], v[56:57], v[74:75]
    v_pk_add_f32 v[58:59], v[58:59], v[154:155]
    v_pk_add_f32 v[60:61], v[60:61], v[90:91]
    v_pk_add_f32 v[62:63], v[62:63], v[170:171]
    v_pk_add_f32 v[56:57], v[56:57], v[76:77]
    v_pk_add_f32 v[58:59], v[58:59], v[156:157]
    v_pk_add_f32 v[60:61], v[60:61], v[92:93]
    v_pk_add_f32 v[62:63], v[62:63], v[172:173]
    v_add_f32 v48, v56, v57
    v_add_f32 v50, v58, v59
    v_add_f32 v52, v60, v61
    v_add_f32 v54, v62, v63
    v_permlane32_swap_b32 v48, v50
    s_nop 0
    v_permlane32_swap_b32 v52, v54
    v_add_f32 v48, v48, v50
    v_add_f32 v52, v52, v54
    v_rcp_f32 v48, v48
    v_rcp_f32 v52, v52
    v_mov_b32 v50, v48
    v_mov_b32 v54, v52
    s_nop 0
    v_permlane32_swap_b32 v48, v50
    v_permlane32_swap_b32 v52, v54
    v_pk_mul_f32 v[64:65], v[64:65], v[48:49] op_sel_hi:[1,0]
    v_pk_mul_f32 v[66:67], v[66:67], v[48:49] op_sel_hi:[1,0]
    v_pk_mul_f32 v[68:69], v[68:69], v[48:49] op_sel_hi:[1,0]
    v_pk_mul_f32 v[70:71], v[70:71], v[48:49] op_sel_hi:[1,0]
    v_pk_mul_f32 v[72:73], v[72:73], v[48:49] op_sel_hi:[1,0]
    v_pk_mul_f32 v[74:75], v[74:75], v[48:49] op_sel_hi:[1,0]
    v_pk_mul_f32 v[76:77], v[76:77], v[48:49] op_sel_hi:[1,0]
    v_cvt_pk_bf16_f32 v192, v64, v65
    v_cvt_pk_bf16_f32 v193, v66, v67
    v_cvt_pk_bf16_f32 v194, v68, v69
    v_cvt_pk_bf16_f32 v195, v70, v71
    v_cvt_pk_bf16_f32 v196, v72, v73
    v_cvt_pk_bf16_f32 v197, v74, v75
    v_cvt_pk_bf16_f32 v198, v76, v77
    v_mov_b32 v199, 0
    v_pk_mul_f32 v[144:145], v[144:145], v[50:51] op_sel_hi:[1,0]
    v_pk_mul_f32 v[146:147], v[146:147], v[50:51] op_sel_hi:[1,0]
    v_pk_mul_f32 v[148:149], v[148:149], v[50:51] op_sel_hi:[1,0]
    v_pk_mul_f32 v[150:151], v[150:151], v[50:51] op_sel_hi:[1,0]
    v_pk_mul_f32 v[152:153], v[152:153], v[50:51] op_sel_hi:[1,0]
    v_pk_mul_f32 v[154:155], v[154:155], v[50:51] op_sel_hi:[1,0]
    v_pk_mul_f32 v[156:157], v[156:157], v[50:51] op_sel_hi:[1,0]
    v_cvt_pk_bf16_f32 v200, v144, v145
    v_cvt_pk_bf16_f32 v201, v146, v147
    v_cvt_pk_bf16_f32 v202, v148, v149
    v_cvt_pk_bf16_f32 v203, v150, v151
    v_cvt_pk_bf16_f32 v204, v152, v153
    v_cvt_pk_bf16_f32 v205, v154, v155
    v_cvt_pk_bf16_f32 v206, v156, v157
    v_mov_b32 v207, 0
    v_pk_mul_f32 v[80:81], v[80:81], v[52:53] op_sel_hi:[1,0]
    v_pk_mul_f32 v[82:83], v[82:83], v[52:53] op_sel_hi:[1,0]
    v_pk_mul_f32 v[84:85], v[84:85], v[52:53] op_sel_hi:[1,0]
    v_pk_mul_f32 v[86:87], v[86:87], v[52:53] op_sel_hi:[1,0]
    v_pk_mul_f32 v[88:89], v[88:89], v[52:53] op_sel_hi:[1,0]
    v_pk_mul_f32 v[90:91], v[90:91], v[52:53] op_sel_hi:[1,0]
    v_pk_mul_f32 v[92:93], v[92:93], v[52:53] op_sel_hi:[1,0]
    v_cvt_pk_bf16_f32 v208, v80, v81
    v_cvt_pk_bf16_f32 v209, v82, v83
    v_cvt_pk_bf16_f32 v210, v84, v85
    v_cvt_pk_bf16_f32 v211, v86, v87
    v_cvt_pk_bf16_f32 v212, v88, v89
    v_cvt_pk_bf16_f32 v213, v90, v91
    v_cvt_pk_bf16_f32 v214, v92, v93
    v_mov_b32 v215, 0
    v_pk_mul_f32 v[160:161], v[160:161], v[54:55] op_sel_hi:[1,0]
    v_pk_mul_f32 v[162:163], v[162:163], v[54:55] op_sel_hi:[1,0]
    v_pk_mul_f32 v[164:165], v[164:165], v[54:55] op_sel_hi:[1,0]
    v_pk_mul_f32 v[166:167], v[166:167], v[54:55] op_sel_hi:[1,0]
    v_pk_mul_f32 v[168:169], v[168:169], v[54:55] op_sel_hi:[1,0]
    v_pk_mul_f32 v[170:171], v[170:171], v[54:55] op_sel_hi:[1,0]
    v_pk_mul_f32 v[172:173], v[172:173], v[54:55] op_sel_hi:[1,0]
    v_cvt_pk_bf16_f32 v216, v160, v161
    v_cvt_pk_bf16_f32 v217, v162, v163
    v_cvt_pk_bf16_f32 v218, v164, v165
    v_cvt_pk_bf16_f32 v219, v166, v167
    v_cvt_pk_bf16_f32 v220, v168, v169
    v_cvt_pk_bf16_f32 v221, v170, v171
    v_cvt_pk_bf16_f32 v222, v172, v173
    v_mov_b32 v223, 0
    v_cvt_pk_bf16_f32 v96, v96, v97
    v_cvt_pk_bf16_f32 v97, v98, v99
    v_cvt_pk_bf16_f32 v98, v100, v101
    v_cvt_pk_bf16_f32 v99, v102, v103
    v_cvt_pk_bf16_f32 v100, v104, v105
    v_cvt_pk_bf16_f32 v101, v106, v107
    v_cvt_pk_bf16_f32 v102, v108, v109
    v_cvt_pk_bf16_f32 v103, v110, v111
    v_mfma_f32_32x32x16_bf16 v[144:159], v[136:139], v[96:99], 0
    s_nop 0
    v_mfma_f32_32x32x16_bf16 v[144:159], v[140:143], v[100:103], v[144:159]
    v_cvt_pk_bf16_f32 v112, v112, v113
    v_cvt_pk_bf16_f32 v113, v114, v115
    v_cvt_pk_bf16_f32 v114, v116, v117
    v_cvt_pk_bf16_f32 v115, v118, v119
    v_cvt_pk_bf16_f32 v116, v120, v121
    v_cvt_pk_bf16_f32 v117, v122, v123
    v_cvt_pk_bf16_f32 v118, v124, v125
    v_cvt_pk_bf16_f32 v119, v126, v127
    v_mfma_f32_32x32x16_bf16 v[160:175], v[136:139], v[112:115], 0
    s_nop 0
    v_mfma_f32_32x32x16_bf16 v[160:175], v[140:143], v[116:119], v[160:175]
    s_nop 0
    v_max3_f32 v48, v144, v145, v146
    v_max3_f32 v50, -v144, -v145, -v146
    v_max3_f32 v48, v48, v147, v148
    v_max3_f32 v50, v50, -v147, -v148
    v_max3_f32 v48, v48, v149, v150
    v_max3_f32 v50, v50, -v149, -v150
    v_max3_f32 v48, v48, v151, v152
    v_max3_f32 v50, v50, -v151, -v152
    v_max3_f32 v48, v48, v153, v154
    v_max3_f32 v50, v50, -v153, -v154
    v_max3_f32 v48, v48, v155, v156
    v_max3_f32 v50, v50, -v155, -v156
    v_max_f32 v48, v48, v157
    v_max_f32_e64 v50, v50, -v157
    v_max3_f32 v52, v160, v161, v162
    v_max3_f32 v54, -v160, -v161, -v162
    v_max3_f32 v52, v52, v163, v164
    v_max3_f32 v54, v54, -v163, -v164
    v_max3_f32 v52, v52, v165, v166
    v_max3_f32 v54, v54, -v165, -v166
    v_max3_f32 v52, v52, v167, v168
    v_max3_f32 v54, v54, -v167, -v168
    v_max3_f32 v52, v52, v169, v170
    v_max3_f32 v54, v54, -v169, -v170
    v_max3_f32 v52, v52, v171, v172
    v_max3_f32 v54, v54, -v171, -v172
    v_max_f32 v52, v52, v173
    v_max_f32_e64 v54, v54, -v173
    v_permlane32_swap_b32 v48, v50
    s_nop 0
    v_permlane32_swap_b32 v52, v54
    v_max_f32 v48, v48, v50
    v_max_f32 v52, v52, v54
    v_mul_f32_e64 v48, -s70, v48
    v_mul_f32_e64 v52, -s70, v52
    v_mov_b32 v50, v48
    v_mov_b32 v54, v52
    s_nop 0
    v_permlane32_swap_b32 v48, v50
    v_permlane32_swap_b32 v52, v54
    v_pk_fma_f32 v[96:97], v[144:145], s[70:71], v[48:49] op_sel_hi:[1,0,0]
    v_pk_fma_f32 v[144:145], v[144:145], s[70:71], v[50:51] op_sel_hi:[1,0,0] neg_lo:[1,0,0] neg_hi:[1,0,0]
    v_pk_fma_f32 v[98:99], v[146:147], s[70:71], v[48:49] op_sel_hi:[1,0,0]
    v_pk_fma_f32 v[146:147], v[146:147], s[70:71], v[50:51] op_sel_hi:[1,0,0] neg_lo:[1,0,0] neg_hi:[1,0,0]
    v_pk_fma_f32 v[100:101], v[148:149], s[70:71], v[48:49] op_sel_hi:[1,0,0]
    v_pk_fma_f32 v[148:149], v[148:149], s[70:71], v[50:51] op_sel_hi:[1,0,0] neg_lo:[1,0,0] neg_hi:[1,0,0]
    v_pk_fma_f32 v[102:103], v[150:151], s[70:71], v[48:49] op_sel_hi:[1,0,0]
    v_pk_fma_f32 v[150:151], v[150:151], s[70:71], v[50:51] op_sel_hi:[1,0,0] neg_lo:[1,0,0] neg_hi:[1,0,0]
    v_pk_fma_f32 v[104:105], v[152:153], s[70:71], v[48:49] op_sel_hi:[1,0,0]
    v_pk_fma_f32 v[152:153], v[152:153], s[70:71], v[50:51] op_sel_hi:[1,0,0] neg_lo:[1,0,0] neg_hi:[1,0,0]
    v_pk_fma_f32 v[106:107], v[154:155], s[70:71], v[48:49] op_sel_hi:[1,0,0]
    v_pk_fma_f32 v[154:155], v[154:155], s[70:71], v[50:51] op_sel_hi:[1,0,0] neg_lo:[1,0,0] neg_hi:[1,0,0]
    v_pk_fma_f32 v[108:109], v[156:157], s[70:71], v[48:49] op_sel_hi:[1,0,0]
    v_pk_fma_f32 v[156:157], v[156:157], s[70:71], v[50:51] op_sel_hi:[1,0,0] neg_lo:[1,0,0] neg_hi:[1,0,0]
    v_pk_fma_f32 v[112:113], v[160:161], s[70:71], v[52:53] op_sel_hi:[1,0,0]
    v_pk_fma_f32 v[160:161], v[160:161], s[70:71], v[54:55] op_sel_hi:[1,0,0] neg_lo:[1,0,0] neg_hi:[1,0,0]
    v_pk_fma_f32 v[114:115], v[162:163], s[70:71], v[52:53] op_sel_hi:[1,0,0]
    v_pk_fma_f32 v[162:163], v[162:163], s[70:71], v[54:55] op_sel_hi:[1,0,0] neg_lo:[1,0,0] neg_hi:[1,0,0]
    v_pk_fma_f32 v[116:117], v[164:165], s[70:71], v[52:53] op_sel_hi:[1,0,0]
    v_pk_fma_f32 v[164:165], v[164:165], s[70:71], v[54:55] op_sel_hi:[1,0,0] neg_lo:[1,0,0] neg_hi:[1,0,0]
    v_pk_fma_f32 v[118:119], v[166:167], s[70:71], v[52:53] op_sel_hi:[1,0,0]
    v_pk_fma_f32 v[166:167], v[166:167], s[70:71], v[54:55] op_sel_hi:[1,0,0] neg_lo:[1,0,0] neg_hi:[1,0,0]
    v_pk_fma_f32 v[120:121], v[168:169], s[70:71], v[52:53] op_sel_hi:[1,0,0]
    v_pk_fma_f32 v[168:169], v[168:169], s[70:71], v[54:55] op_sel_hi:[1,0,0] neg_lo:[1,0,0] neg_hi:[1,0,0]
    v_pk_fma_f32 v[122:123], v[170:171], s[70:71], v[52:53] op_sel_hi:[1,0,0]
    v_pk_fma_f32 v[170:171], v[170:171], s[70:71], v[54:55] op_sel_hi:[1,0,0] neg_lo:[1,0,0] neg_hi:[1,0,0]
    v_pk_fma_f32 v[124:125], v[172:173], s[70:71], v[52:53] op_sel_hi:[1,0,0]
    v_pk_fma_f32 v[172:173], v[172:173], s[70:71], v[54:55] op_sel_hi:[1,0,0] neg_lo:[1,0,0] neg_hi:[1,0,0]
    v_exp_f32 v96, v96
    v_exp_f32 v144, v144
    v_exp_f32 v97, v97
    v_exp_f32 v145, v145
    v_exp_f32 v98, v98
    v_exp_f32 v146, v146
    v_exp_f32 v99, v99
    v_exp_f32 v147, v147
    v_exp_f32 v100, v100
    v_exp_f32 v148, v148
    v_exp_f32 v101, v101
    v_exp_f32 v149, v149
    v_exp_f32 v102, v102
    v_exp_f32 v150, v150
    v_exp_f32 v103, v103
    v_exp_f32 v151, v151
    v_exp_f32 v104, v104
    v_exp_f32 v152, v152
    v_exp_f32 v105, v105
    v_exp_f32 v153, v153
    v_exp_f32 v106, v106
    v_exp_f32 v154, v154
    v_exp_f32 v107, v107
    v_exp_f32 v155, v155
    v_exp_f32 v108, v108
    v_exp_f32 v156, v156
    v_exp_f32 v109, v109
    v_exp_f32 v157, v157
    v_exp_f32 v112, v112
    v_exp_f32 v160, v160
    v_exp_f32 v113, v113
    v_exp_f32 v161, v161
    v_exp_f32 v114, v114
    v_exp_f32 v162, v162
    v_exp_f32 v115, v115
    v_exp_f32 v163, v163
    v_exp_f32 v116, v116
    v_exp_f32 v164, v164
    v_exp_f32 v117, v117
    v_exp_f32 v165, v165
    v_exp_f32 v118, v118
    v_exp_f32 v166, v166
    v_exp_f32 v119, v119
    v_exp_f32 v167, v167
    v_and_b32 v28, 0x400, v23
    v_add_u32 v23, v23, v28
    v_lshlrev_b32 v23, 3, v23
    s_add_u32 s11, s84, 764
    s_cmp_lt_u32 s60, 4
    s_cselect_b32 s11, s11, 0x4000000
    buffer_load_dword v16, v23, s[40:43], s11 offen sc1
    v_exp_f32 v120, v120
    v_exp_f32 v168, v168
    v_exp_f32 v121, v121
    v_exp_f32 v169, v169
    v_exp_f32 v122, v122
    v_exp_f32 v170, v170
    v_exp_f32 v123, v123
    v_exp_f32 v171, v171
    v_exp_f32 v124, v124
    v_exp_f32 v172, v172
    v_exp_f32 v125, v125
    v_exp_f32 v173, v173
    v_cvt_pk_bf16_f32 v224, v96, v97
    v_cvt_pk_bf16_f32 v225, v98, v99
    v_cvt_pk_bf16_f32 v226, v100, v101
    v_cvt_pk_bf16_f32 v227, v102, v103
    v_cvt_pk_bf16_f32 v228, v104, v105
    v_cvt_pk_bf16_f32 v229, v106, v107
    v_cvt_pk_bf16_f32 v230, v108, v109
    v_mov_b32 v231, 0
    v_cvt_pk_bf16_f32 v232, v144, v145
    v_cvt_pk_bf16_f32 v233, v146, v147
    v_cvt_pk_bf16_f32 v234, v148, v149
    v_cvt_pk_bf16_f32 v235, v150, v151
    v_cvt_pk_bf16_f32 v236, v152, v153
    v_cvt_pk_bf16_f32 v237, v154, v155
    v_cvt_pk_bf16_f32 v238, v156, v157
    v_mov_b32 v239, 0
    v_cvt_pk_bf16_f32 v240, v112, v113
    v_cvt_pk_bf16_f32 v241, v114, v115
    v_cvt_pk_bf16_f32 v242, v116, v117
    v_cvt_pk_bf16_f32 v243, v118, v119
    v_cvt_pk_bf16_f32 v244, v120, v121
    v_cvt_pk_bf16_f32 v245, v122, v123
    v_cvt_pk_bf16_f32 v246, v124, v125
    v_mov_b32 v247, 0
    v_cvt_pk_bf16_f32 v248, v160, v161
    v_cvt_pk_bf16_f32 v249, v162, v163
    v_cvt_pk_bf16_f32 v250, v164, v165
    v_cvt_pk_bf16_f32 v251, v166, v167
    v_cvt_pk_bf16_f32 v252, v168, v169
    v_cvt_pk_bf16_f32 v253, v170, v171
    v_cvt_pk_bf16_f32 v254, v172, v173
    v_mov_b32 v255, 0
    s_cmp_ge_u32 s60, 4
    s_cbranch_scc1 L_q_sum
    v_and_b32 v29, 31, v0
    v_cmp_eq_u32 vcc, 29, v29
    v_mov_b32 v71, 0
    v_mov_b32 v79, 0
    v_mov_b32 v87, 0
    v_mov_b32 v95, 0
    v_mov_b32 v103, 0
    v_mov_b32 v111, 0
    v_mov_b32 v119, 0
    v_mov_b32 v127, 0
    v_cndmask_b32_e64 v128, 0, 1.0, vcc
    v_cndmask_b32_e64 v129, 0, 1.0, vcc
    v_cndmask_b32_e64 v130, 0, 1.0, vcc
    v_cndmask_b32_e64 v131, 0, 1.0, vcc
    v_cndmask_b32_e64 v132, 0, 1.0, vcc
    v_cndmask_b32_e64 v133, 0, 1.0, vcc
    v_cndmask_b32_e64 v134, 0, 1.0, vcc
    v_cndmask_b32_e64 v135, 0, 1.0, vcc
    v_cndmask_b32_e64 v136, 0, 1.0, vcc
    v_cndmask_b32_e64 v137, 0, 1.0, vcc
    v_cndmask_b32_e64 v138, 0, 1.0, vcc
    v_cndmask_b32_e64 v139, 0, 1.0, vcc
    v_cndmask_b32_e64 v140, 0, 1.0, vcc
    v_cndmask_b32_e64 v141, 0, 1.0, vcc
    v_cndmask_b32_e64 v142, 0, 1.0, vcc
    v_cndmask_b32_e64 v143, 0, 1.0, vcc
    s_mov_b32 s81, 4096
    s_mov_b32 s75, 40000
    v_mov_b32 v28, 0
    s_branch L_see0
L_q_redo:
    v_mov_b32 v28, 0
L_ask0:
    buffer_load_dword v16, v23, s[40:43], s11 offen sc1
L_see0:
    s_waitcnt vmcnt(0)
    v_cmp_ne_u32 vcc, -1, v16
    s_sub_u32 s75, s75, 1
    s_cmp_lt_i32 s75, 0
    s_cselect_b32 s63, -1, 0
    s_nop 1
    s_lshr_b32 s80, vcc_lo, 8
    s_and_b32 s80, s80, vcc_lo
    s_or_b32 s80, s80, s63
    s_and_b32 s80, s80, 0xff
    s_and_b32 s63, s80, 15
    s_lshr_b32 s64, s80, 4
    s_max_u32 s64, s64, s63
    s_cmp_eq_u32 s64, 15
    s_cbranch_scc1 L_got0
    s_sleep 1
    s_branch L_ask0
L_got0:
    s_cmp_eq_u32 s63, 15
    s_cselect_b32 s63, 0, 4096
    s_add_u32 s4, s83, s63
    s_add_u32 s5, s4, 8192
    s_add_u32 s6, s4, 16384
    s_add_u32 s7, s4, 24576
    buffer_load_dwordx4 v[64:67], v184, s[40:43], s4 offen sc1
    buffer_load_dwordx3 v[68:70], v185, s[40:43], s5 offen sc1
    buffer_load_dwordx4 v[72:75], v184, s[40:43], s6 offen sc1
    buffer_load_dwordx3 v[76:78], v185, s[40:43], s7 offen sc1
    buffer_load_dwordx4 v[80:83], v186, s[40:43], s4 offen sc1
    buffer_load_dwordx3 v[84:86], v187, s[40:43], s5 offen sc1
    buffer_load_dwordx4 v[88:91], v186, s[40:43], s6 offen sc1
    buffer_load_dwordx3 v[92:94], v187, s[40:43], s7 offen sc1
    buffer_load_dwordx4 v[96:99], v188, s[40:43], s4 offen sc1
    buffer_load_dwordx3 v[100:102], v189, s[40:43], s5 offen sc1
    buffer_load_dwordx4 v[104:107], v188, s[40:43], s6 offen sc1
    buffer_load_dwordx3 v[108:110], v189, s[40:43], s7 offen sc1
    buffer_load_dword v16, v23, s[40:43], s11 offen sc1
    s_waitcnt vmcnt(12)
    v_mfma_f32_32x32x16_bf16 v[144:159], v[176:179], v[64:67], v[128:143]
    v_max3_u32 v28, v28, v64, v65
    v_max3_u32 v28, v28, v66, v67
    buffer_load_dwordx4 v[112:115], v190, s[40:43], s4 offen sc1
    s_waitcnt vmcnt(12)
    v_mfma_f32_32x32x16_bf16 v[144:159], v[180:183], v[68:71], v[144:159]
    v_max3_u32 v28, v28, v68, v69
    buffer_load_dwordx3 v[116:118], v191, s[40:43], s5 offen sc1
    s_waitcnt vmcnt(12)
    v_mfma_f32_32x32x16_bf16 v[160:175], v[176:179], v[72:75], v[128:143]
    v_max3_u32 v28, v28, v70, v72
    v_max3_u32 v28, v28, v73, v74
    buffer_load_dwordx4 v[120:123], v190, s[40:43], s6 offen sc1
    s_waitcnt vmcnt(12)
    v_mfma_f32_32x32x16_bf16 v[160:175], v[180:183], v[76:79], v[160:175]
    v_max3_u32 v28, v28, v75, v76
    v_max3_u32 v28, v28, v77, v78
    buffer_load_dwordx3 v[124:126], v191, s[40:43], s7 offen sc1
    s_xor_b32 s4, s4, 4096
    s_xor_b32 s5, s5, 4096
    s_xor_b32 s6, s6, 4096
    s_xor_b32 s7, s7, 4096
    s_waitcnt vmcnt(12)
    v_mfma_f32_32x32x16_bf16 v[144:159], v[176:179], v[80:83], v[144:159]
    v_max3_u32 v28, v28, v80, v81
    v_max3_u32 v28, v28, v82, v83
    s_waitcnt vmcnt(11)
    v_mfma_f32_32x32x16_bf16 v[144:159], v[180:183], v[84:87], v[144:159]
    v_max3_u32 v28, v28, v84, v85
    s_waitcnt vmcnt(10)
    v_mfma_f32_32x32x16_bf16 v[160:175], v[176:179], v[88:91], v[160:175]
    v_max3_u32 v28, v28, v86, v88
    v_max3_u32 v28, v28, v89, v90
    s_waitcnt vmcnt(9)
    v_mfma_f32_32x32x16_bf16 v[160:175], v[180:183], v[92:95], v[160:175]
    v_max3_u32 v28, v28, v91, v92
    v_max3_u32 v28, v28, v93, v94
    s_waitcnt vmcnt(4)
    v_cmp_eq_u32 vcc, -1, v16
    s_nop 1
    s_and_b32 s74, vcc_lo, 65535
    s_cbranch_scc1 L_q_half
    buffer_load_dwordx4 v[64:67], v184, s[40:43], s4 offen sc1
    buffer_load_dwordx3 v[68:70], v185, s[40:43], s5 offen sc1
    buffer_load_dwordx4 v[72:75], v184, s[40:43], s6 offen sc1
    buffer_load_dwordx3 v[76:78], v185, s[40:43], s7 offen sc1
    v_mfma_f32_32x32x16_bf16 v[144:159], v[176:179], v[96:99], v[144:159]
    v_max3_u32 v28, v28, v96, v97
    v_max3_u32 v28, v28, v98, v99
    buffer_load_dwordx4 v[80:83], v186, s[40:43], s4 offen sc1
    v_mfma_f32_32x32x16_bf16 v[144:159], v[180:183], v[100:103], v[144:159]
    v_max3_u32 v28, v28, v100, v101
    buffer_load_dwordx3 v[84:86], v187, s[40:43], s5 offen sc1
    v_mfma_f32_32x32x16_bf16 v[160:175], v[176:179], v[104:107], v[160:175]
    v_max3_u32 v28, v28, v102, v104
    v_max3_u32 v28, v28, v105, v106
    buffer_load_dwordx4 v[88:91], v186, s[40:43], s6 offen sc1
    v_mfma_f32_32x32x16_bf16 v[160:175], v[180:183], v[108:111], v[160:175]
    v_max3_u32 v28, v28, v107, v108
    v_max3_u32 v28, v28, v109, v110
    buffer_load_dwordx3 v[92:94], v187, s[40:43], s7 offen sc1
    s_waitcnt vmcnt(11)
    v_mfma_f32_32x32x16_bf16 v[144:159], v[176:179], v[112:115], v[144:159]
    v_max3_u32 v28, v28, v112, v113
    v_max3_u32 v28, v28, v114, v115
    buffer_load_dwordx4 v[96:99], v188, s[40:43], s4 offen sc1
    s_waitcnt vmcnt(11)
    v_mfma_f32_32x32x16_bf16 v[144:159], v[180:183], v[116:119], v[144:159]
    v_max3_u32 v28, v28, v116, v117
    buffer_load_dwordx3 v[100:102], v189, s[40:43], s5 offen sc1
    s_waitcnt vmcnt(11)
    v_mfma_f32_32x32x16_bf16 v[160:175], v[176:179], v[120:123], v[160:175]
    v_max3_u32 v28, v28, v118, v120
    v_max3_u32 v28, v28, v121, v122
    buffer_load_dwordx4 v[104:107], v188, s[40:43], s6 offen sc1
    s_waitcnt vmcnt(11)
    v_mfma_f32_32x32x16_bf16 v[160:175], v[180:183], v[124:127], v[160:175]
    v_max3_u32 v28, v28, v123, v124
    v_max3_u32 v28, v28, v125, v126
    buffer_load_dwordx3 v[108:110], v189, s[40:43], s7 offen sc1
L_q_both:
    s_waitcnt vmcnt(11)
    v_mfma_f32_32x32x16_bf16 v[144:159], v[176:179], v[64:67], v[144:159]
    v_max3_u32 v28, v28, v64, v65
    v_max3_u32 v28, v28, v66, v67
    buffer_load_dwordx4 v[112:115], v190, s[40:43], s4 offen sc1
    s_waitcnt vmcnt(11)
    v_mfma_f32_32x32x16_bf16 v[144:159], v[180:183], v[68:71], v[144:159]
    v_max3_u32 v28, v28, v68, v69
    buffer_load_dwordx3 v[116:118], v191, s[40:43], s5 offen sc1
    s_waitcnt vmcnt(11)
    v_mfma_f32_32x32x16_bf16 v[160:175], v[176:179], v[72:75], v[160:175]
    v_max3_u32 v28, v28, v70, v72
    v_max3_u32 v28, v28, v73, v74
    buffer_load_dwordx4 v[120:123], v190, s[40:43], s6 offen sc1
    s_waitcnt vmcnt(11)
    v_mfma_f32_32x32x16_bf16 v[160:175], v[180:183], v[76:79], v[160:175]
    v_max3_u32 v28, v28, v75, v76
    v_max3_u32 v28, v28, v77, v78
    buffer_load_dwordx3 v[124:126], v191, s[40:43], s7 offen sc1
    s_waitcnt vmcnt(11)
    v_mfma_f32_32x32x16_bf16 v[144:159], v[176:179], v[80:83], v[144:159]
    v_max3_u32 v28, v28, v80, v81
    v_max3_u32 v28, v28, v82, v83
    s_waitcnt vmcnt(10)
    v_mfma_f32_32x32x16_bf16 v[144:159], v[180:183], v[84:87], v[144:159]
    v_max3_u32 v28, v28, v84, v85
    s_waitcnt vmcnt(9)
    v_mfma_f32_32x32x16_bf16 v[160:175], v[176:179], v[88:91], v[160:175]
    v_max3_u32 v28, v28, v86, v88
    v_max3_u32 v28, v28, v89, v90
    s_waitcnt vmcnt(8)
    v_mfma_f32_32x32x16_bf16 v[160:175], v[180:183], v[92:95], v[160:175]
    v_max3_u32 v28, v28, v91, v92
    v_max3_u32 v28, v28, v93, v94
    s_waitcnt vmcnt(7)
    v_mfma_f32_32x32x16_bf16 v[144:159], v[176:179], v[96:99], v[144:159]
    v_max3_u32 v28, v28, v96, v97
    v_max3_u32 v28, v28, v98, v99
    s_waitcnt vmcnt(6)
    v_mfma_f32_32x32x16_bf16 v[144:159], v[180:183], v[100:103], v[144:159]
    v_max3_u32 v28, v28, v100, v101
    s_waitcnt vmcnt(5)
    v_mfma_f32_32x32x16_bf16 v[160:175], v[176:179], v[104:107], v[160:175]
    v_max3_u32 v28, v28, v102, v104
    v_max3_u32 v28, v28, v105, v106
    s_waitcnt vmcnt(4)
    v_mfma_f32_32x32x16_bf16 v[160:175], v[180:183], v[108:111], v[160:175]
    v_max3_u32 v28, v28, v107, v108
    v_max3_u32 v28, v28, v109, v110
    s_waitcnt vmcnt(3)
    v_mfma_f32_32x32x16_bf16 v[144:159], v[176:179], v[112:115], v[144:159]
    v_max3_u32 v28, v28, v112, v113
    v_max3_u32 v28, v28, v114, v115
    s_waitcnt vmcnt(2)
    v_mfma_f32_32x32x16_bf16 v[144:159], v[180:183], v[116:119], v[144:159]
    v_max3_u32 v28, v28, v116, v117
    s_waitcnt vmcnt(1)
    v_mfma_f32_32x32x16_bf16 v[160:175], v[176:179], v[120:123], v[160:175]
    v_max3_u32 v28, v28, v118, v120
    v_max3_u32 v28, v28, v121, v122
    s_waitcnt vmcnt(0)
    v_mfma_f32_32x32x16_bf16 v[160:175], v[180:183], v[124:127], v[160:175]
    v_max3_u32 v28, v28, v123, v124
    v_max3_u32 v28, v28, v125, v126
    v_cmp_eq_u32 vcc, -1, v28
    s_sub_u32 s81, s81, 1
    s_nop 0
    s_cselect_b64 s[76:77], 0, vcc
    s_cmp_lg_u64 s[76:77], 0
    s_cbranch_scc1 L_q_redo
    v_cvt_pk_bf16_f32 v144, v144, v145
    v_cvt_pk_bf16_f32 v145, v146, v147
    v_cvt_pk_bf16_f32 v146, v148, v149
    v_cvt_pk_bf16_f32 v147, v150, v151
    ds_write_b128 v20, v[144:147] offset:0
    v_cvt_pk_bf16_f32 v148, v152, v153
    v_cvt_pk_bf16_f32 v149, v154, v155
    v_cvt_pk_bf16_f32 v150, v156, v157
    v_cvt_pk_bf16_f32 v151, v158, v159
    ds_write_b128 v20, v[148:151] offset:1024
    v_cvt_pk_bf16_f32 v160, v160, v161
    v_cvt_pk_bf16_f32 v161, v162, v163
    v_cvt_pk_bf16_f32 v162, v164, v165
    v_cvt_pk_bf16_f32 v163, v166, v167
    ds_write_b128 v20, v[160:163] offset:2048
    v_cvt_pk_bf16_f32 v164, v168, v169
    v_cvt_pk_bf16_f32 v165, v170, v171
    v_cvt_pk_bf16_f32 v166, v172, v173
    v_cvt_pk_bf16_f32 v167, v174, v175
    ds_write_b128 v20, v[164:167] offset:3072
    s_setprio 1
L_q_sum:
    s_waitcnt lgkmcnt(0)
    s_barrier
    ds_read_b128 v[32:35], v21 offset:0
    ds_read_b128 v[36:39], v21 offset:1024
    ds_read_b128 v[40:43], v21 offset:2048
    ds_read_b128 v[44:47], v21 offset:3072
    ds_read_b128 v[48:51], v21 offset:4096
    ds_read_b128 v[52:55], v21 offset:5120
    ds_read_b128 v[56:59], v21 offset:6144
    ds_read_b128 v[60:63], v21 offset:7168
    v_mov_b32 v29, 0x358637bd
    s_waitcnt lgkmcnt(7)
    v_mfma_f32_32x32x16_bf16 v[64:79], v[32:35], v[192:195], 0
    s_waitcnt lgkmcnt(6)
    v_mfma_f32_32x32x16_bf16 v[64:79], v[36:39], v[196:199], v[64:79]
    s_waitcnt lgkmcnt(5)
    v_mfma_f32_32x32x16_bf16 v[64:79], v[40:43], v[200:203], v[64:79]
    s_waitcnt lgkmcnt(4)
    v_mfma_f32_32x32x16_bf16 v[64:79], v[44:47], v[204:207], v[64:79]
    v_mfma_f32_32x32x16_bf16 v[96:111], v[32:35], v[208:211], 0
    v_mfma_f32_32x32x16_bf16 v[96:111], v[36:39], v[212:215], v[96:111]
    v_mfma_f32_32x32x16_bf16 v[96:111], v[40:43], v[216:219], v[96:111]
    s_nop 8
    v_add_f32 v78, 0x358637bd, v78
    v_rcp_f32 v78, v78
    s_nop 0
    v_mul_f32 v78, v78, v2
    v_mul_f32 v64, v64, v78
    v_mul_f32 v65, v65, v78
    v_mfma_f32_32x32x16_bf16 v[96:111], v[44:47], v[220:223], v[96:111]
    v_mul_f32 v66, v66, v78
    v_mul_f32 v67, v67, v78
    v_mul_f32 v68, v68, v78
    v_mul_f32 v69, v69, v78
    v_mul_f32 v70, v70, v78
    v_mul_f32 v71, v71, v78
    s_waitcnt lgkmcnt(3)
    v_mfma_f32_32x32x16_bf16 v[128:143], v[48:51], v[224:227], 0
    v_mul_f32 v72, v72, v78
    v_mul_f32 v73, v73, v78
    v_mul_f32 v74, v74, v78
    v_mul_f32 v75, v75, v78
    v_mul_f32 v76, v76, v78
    v_mul_f32 v77, v77, v78
    v_cvt_pk_bf16_f32 v64, v64, v65
    s_waitcnt lgkmcnt(2)
    v_mfma_f32_32x32x16_bf16 v[128:143], v[52:55], v[228:231], v[128:143]
    v_cvt_pk_bf16_f32 v65, v66, v67
    v_cvt_pk_bf16_f32 v66, v68, v69
    v_cvt_pk_bf16_f32 v67, v70, v71
    buffer_store_dwordx4 v[64:67], v1, s[40:43], s85 offen offset:0 sc1
    v_cvt_pk_bf16_f32 v68, v72, v73
    v_cvt_pk_bf16_f32 v69, v74, v75
    v_cvt_pk_bf16_f32 v70, v76, v77
    buffer_store_dwordx3 v[68:70], v22, s[40:43], s85 offen offset:1024 sc1
    s_waitcnt lgkmcnt(1)
    v_mfma_f32_32x32x16_bf16 v[144:159], v[56:59], v[232:235], 0
    v_add_f32 v110, 0x358637bd, v110
    v_rcp_f32 v110, v110
    s_nop 0
    v_mul_f32 v110, v110, v3
    v_mul_f32 v96, v96, v110
    v_mul_f32 v97, v97, v110
    s_waitcnt lgkmcnt(0)
    v_mfma_f32_32x32x16_bf16 v[144:159], v[60:63], v[236:239], v[144:159]
    v_mul_f32 v98, v98, v110
    v_mul_f32 v99, v99, v110
    v_mul_f32 v100, v100, v110
    v_mul_f32 v101, v101, v110
    v_mul_f32 v102, v102, v110
    v_mul_f32 v103, v103, v110
    v_mfma_f32_32x32x16_bf16 v[160:175], v[48:51], v[240:243], 0
    v_mul_f32 v104, v104, v110
    v_mul_f32 v105, v105, v110
    v_mul_f32 v106, v106, v110
    v_mul_f32 v107, v107, v110
    v_mul_f32 v108, v108, v110
    v_mul_f32 v109, v109, v110
    v_cvt_pk_bf16_f32 v96, v96, v97
    v_mfma_f32_32x32x16_bf16 v[160:175], v[52:55], v[244:247], v[160:175]
    v_cvt_pk_bf16_f32 v97, v98, v99
    v_cvt_pk_bf16_f32 v98, v100, v101
    v_cvt_pk_bf16_f32 v99, v102, v103
    buffer_store_dwordx4 v[96:99], v1, s[40:43], s86 offen offset:0 sc1
    v_cvt_pk_bf16_f32 v100, v104, v105
    v_cvt_pk_bf16_f32 v101, v106, v107
    v_cvt_pk_bf16_f32 v102, v108, v109
    buffer_store_dwordx3 v[100:102], v22, s[40:43], s86 offen offset:1024 sc1
    v_mfma_f32_32x32x16_bf16 v[176:191], v[56:59], v[248:251], 0
    v_rcp_f32 v143, v143
    v_rcp_f32 v159, v159
    v_fma_f32 v142, v142, v143, v29
    v_fmac_f32 v142, v158, v159
    v_rcp_f32 v142, v142
    v_mul_f32 v143, v143, v2
    v_mul_f32 v159, v159, v2
    v_mul_f32 v159, v159, v142
    v_mul_f32 v142, v143, v142
    v_mul_f32 v128, v128, v142
    v_mul_f32 v129, v129, v142
    v_mul_f32 v130, v130, v142
    v_mul_f32 v131, v131, v142
    v_mul_f32 v132, v132, v142
    v_mul_f32 v133, v133, v142
    v_mul_f32 v134, v134, v142
    v_mul_f32 v135, v135, v142
    v_mul_f32 v136, v136, v142
    v_mul_f32 v137, v137, v142
    v_mul_f32 v138, v138, v142
    v_mfma_f32_32x32x16_bf16 v[176:191], v[60:63], v[252:255], v[176:191]
    v_mul_f32 v139, v139, v142
    v_mul_f32 v140, v140, v142
    v_mul_f32 v141, v141, v142
    v_fmac_f32 v128, v144, v159
    v_fmac_f32 v129, v145, v159
    v_fmac_f32 v130, v146, v159
    v_fmac_f32 v131, v147, v159
    v_fmac_f32 v132, v148, v159
    v_fmac_f32 v133, v149, v159
    v_fmac_f32 v134, v150, v159
    v_fmac_f32 v135, v151, v159
    v_fmac_f32 v136, v152, v159
    v_fmac_f32 v137, v153, v159
    v_fmac_f32 v138, v154, v159
    v_fmac_f32 v139, v155, v159
    v_fmac_f32 v140, v156, v159
    v_fmac_f32 v141, v157, v159
    v_cvt_pk_bf16_f32 v128, v128, v129
    v_cvt_pk_bf16_f32 v129, v130, v131
    v_cvt_pk_bf16_f32 v130, v132, v133
    v_cvt_pk_bf16_f32 v131, v134, v135
    buffer_store_dwordx4 v[128:131], v1, s[40:43], s85 offen offset:2048 sc1
    v_cvt_pk_bf16_f32 v132, v136, v137
    v_cvt_pk_bf16_f32 v133, v138, v139
    v_cvt_pk_bf16_f32 v134, v140, v141
    buffer_store_dwordx3 v[132:134], v22, s[40:43], s85 offen offset:3072 sc1
    v_rcp_f32 v175, v175
    v_rcp_f32 v191, v191
    v_fma_f32 v174, v174, v175, v29
    v_fmac_f32 v174, v190, v191
    v_rcp_f32 v174, v174
    v_mul_f32 v175, v175, v3
    v_mul_f32 v191, v191, v3
    v_mul_f32 v191, v191, v174
    v_mul_f32 v174, v175, v174
    v_mul_f32 v160, v160, v174
    v_mul_f32 v161, v161, v174
    v_mul_f32 v162, v162, v174
    v_mul_f32 v163, v163, v174
    v_mul_f32 v164, v164, v174
    v_mul_f32 v165, v165, v174
    v_mul_f32 v166, v166, v174
    v_mul_f32 v167, v167, v174
    v_mul_f32 v168, v168, v174
    v_mul_f32 v169, v169, v174
    v_mul_f32 v170, v170, v174
    v_mul_f32 v171, v171, v174
    v_mul_f32 v172, v172, v174
    v_mul_f32 v173, v173, v174
    v_fmac_f32 v160, v176, v191
    v_fmac_f32 v161, v177, v191
    v_fmac_f32 v162, v178, v191
    v_fmac_f32 v163, v179, v191
    v_fmac_f32 v164, v180, v191
    v_fmac_f32 v165, v181, v191
    v_fmac_f32 v166, v182, v191
    v_fmac_f32 v167, v183, v191
    v_fmac_f32 v168, v184, v191
    v_fmac_f32 v169, v185, v191
    v_fmac_f32 v170, v186, v191
    v_fmac_f32 v171, v187, v191
    v_fmac_f32 v172, v188, v191
    v_fmac_f32 v173, v189, v191
    v_cvt_pk_bf16_f32 v160, v160, v161
    v_cvt_pk_bf16_f32 v161, v162, v163
    v_cvt_pk_bf16_f32 v162, v164, v165
    v_cvt_pk_bf16_f32 v163, v166, v167
    buffer_store_dwordx4 v[160:163], v1, s[40:43], s86 offen offset:2048 sc1
    v_cvt_pk_bf16_f32 v164, v168, v169
    v_cvt_pk_bf16_f32 v165, v170, v171
    v_cvt_pk_bf16_f32 v166, v172, v173
    buffer_store_dwordx3 v[164:166], v22, s[40:43], s86 offen offset:3072 sc1
    s_waitcnt vmcnt(0)
    buffer_store_dword v18, v17, s[40:43], s3 offen sc1
    s_branch L_fin
L_q_half:
    v_mfma_f32_32x32x16_bf16 v[144:159], v[176:179], v[96:99], v[144:159]
    v_max3_u32 v28, v28, v96, v97
    v_max3_u32 v28, v28, v98, v99
    v_mfma_f32_32x32x16_bf16 v[144:159], v[180:183], v[100:103], v[144:159]
    v_max3_u32 v28, v28, v100, v101
    v_mfma_f32_32x32x16_bf16 v[160:175], v[176:179], v[104:107], v[160:175]
    v_max3_u32 v28, v28, v102, v104
    v_max3_u32 v28, v28, v105, v106
    v_mfma_f32_32x32x16_bf16 v[160:175], v[180:183], v[108:111], v[160:175]
    v_max3_u32 v28, v28, v107, v108
    v_max3_u32 v28, v28, v109, v110
    s_waitcnt vmcnt(3)
    v_mfma_f32_32x32x16_bf16 v[144:159], v[176:179], v[112:115], v[144:159]
    v_max3_u32 v28, v28, v112, v113
    v_max3_u32 v28, v28, v114, v115
    s_waitcnt vmcnt(2)
    v_mfma_f32_32x32x16_bf16 v[144:159], v[180:183], v[116:119], v[144:159]
    v_max3_u32 v28, v28, v116, v117
    s_waitcnt vmcnt(1)
    v_mfma_f32_32x32x16_bf16 v[160:175], v[176:179], v[120:123], v[160:175]
    v_max3_u32 v28, v28, v118, v120
    v_max3_u32 v28, v28, v121, v122
    s_waitcnt vmcnt(0)
    v_mfma_f32_32x32x16_bf16 v[160:175], v[180:183], v[124:127], v[160:175]
    v_max3_u32 v28, v28, v123, v124
    v_max3_u32 v28, v28, v125, v126
L_ask1:
    buffer_load_dword v16, v23, s[40:43], s11 offen sc1
L_see1:
    s_waitcnt vmcnt(0)
    v_cmp_ne_u32 vcc, -1, v16
    s_sub_u32 s75, s75, 1
    s_cmp_lt_i32 s75, 0
    s_cselect_b32 s63, -1, 0
    s_nop 1
    s_lshr_b32 s80, vcc_lo, 8
    s_and_b32 s80, s80, vcc_lo
    s_or_b32 s80, s80, s63
    s_and_b32 s80, s80, 0xff
    s_cmp_eq_u32 s80, 0xff
    s_cbranch_scc1 L_got1
    s_sleep 1
    s_branch L_ask1
L_got1:
    buffer_load_dwordx4 v[64:67], v184, s[40:43], s4 offen sc1
    buffer_load_dwordx3 v[68:70], v185, s[40:43], s5 offen sc1
    buffer_load_dwordx4 v[72:75], v184, s[40:43], s6 offen sc1
    buffer_load_dwordx3 v[76:78], v185, s[40:43], s7 offen sc1
    buffer_load_dwordx4 v[80:83], v186, s[40:43], s4 offen sc1
    buffer_load_dwordx3 v[84:86], v187, s[40:43], s5 offen sc1
    buffer_load_dwordx4 v[88:91], v186, s[40:43], s6 offen sc1
    buffer_load_dwordx3 v[92:94], v187, s[40:43], s7 offen sc1
    buffer_load_dwordx4 v[96:99], v188, s[40:43], s4 offen sc1
    buffer_load_dwordx3 v[100:102], v189, s[40:43], s5 offen sc1
    buffer_load_dwordx4 v[104:107], v188, s[40:43], s6 offen sc1
    buffer_load_dwordx3 v[108:110], v189, s[40:43], s7 offen sc1
    s_branch L_q_both
L_o_late:
    buffer_load_dwordx4 v[216:219], v1, s[40:43], s85 offen offset:0 sc1
    v_mov_b32 v223, 0
    buffer_load_dwordx3 v[220:222], v5, s[40:43], s85 offen offset:1024 sc1
    buffer_load_dwordx4 v[224:227], v1, s[40:43], s85 offen offset:2048 sc1
    v_mov_b32 v231, 0
    buffer_load_dwordx3 v[228:230], v5, s[40:43], s85 offen offset:3072 sc1
    buffer_load_dwordx4 v[232:235], v1, s[40:43], s86 offen offset:0 sc1
    v_mov_b32 v239, 0
    buffer_load_dwordx3 v[236:238], v5, s[40:43], s86 offen offset:1024 sc1
    buffer_load_dwordx4 v[240:243], v1, s[40:43], s86 offen offset:2048 sc1
    v_mov_b32 v247, 0
    buffer_load_dwordx3 v[244:246], v5, s[40:43], s86 offen offset:3072 sc1
    v_mfma_f32_32x32x16_bf16 v[64:79], v[96:99], v[200:203], v[64:79]
    v_mfma_f32_32x32x16_bf16 v[128:143], v[100:103], v[200:203], v[128:143]
    s_waitcnt vmcnt(10)
    v_mfma_f32_32x32x16_bf16 v[64:79], v[104:107], v[204:207], v[64:79]
    v_mfma_f32_32x32x16_bf16 v[128:143], v[108:111], v[204:207], v[128:143]
    s_waitcnt vmcnt(9)
    v_mfma_f32_32x32x16_bf16 v[64:79], v[112:115], v[208:211], v[64:79]
    v_mfma_f32_32x32x16_bf16 v[128:143], v[116:119], v[208:211], v[128:143]
    s_waitcnt vmcnt(8)
    v_mfma_f32_32x32x16_bf16 v[64:79], v[120:123], v[212:215], v[64:79]
    v_mfma_f32_32x32x16_bf16 v[128:143], v[124:127], v[212:215], v[128:143]
    s_waitcnt vmcnt(7) lgkmcnt(6)
    v_mfma_f32_32x32x16_bf16 v[32:47], v[80:83], v[216:219], v[32:47]
    s_waitcnt lgkmcnt(4)
    v_mfma_f32_32x32x16_bf16 v[48:63], v[84:87], v[216:219], v[48:63]
    s_waitcnt vmcnt(6) lgkmcnt(2)
    v_mfma_f32_32x32x16_bf16 v[32:47], v[88:91], v[220:223], v[32:47]
    s_nop 4
    v_mul_f32 v64, v64, v253
    v_mul_f32 v65, v65, v253
    v_mul_f32 v66, v66, v253
    v_mul_f32 v67, v67, v253
    v_mul_f32 v68, v68, v253
    s_waitcnt lgkmcnt(0)
    v_mfma_f32_32x32x16_bf16 v[48:63], v[92:95], v[220:223], v[48:63]
    v_mul_f32 v69, v69, v253
    v_mul_f32 v70, v70, v253
    v_mul_f32 v71, v71, v253
    v_mul_f32 v72, v72, v253
    v_mul_f32 v73, v73, v253
    v_mul_f32 v74, v74, v253
    s_waitcnt vmcnt(5)
    v_mfma_f32_32x32x16_bf16 v[32:47], v[144:147], v[224:227], v[32:47]
    v_mul_f32 v75, v75, v253
    v_mul_f32 v76, v76, v253
    v_mul_f32 v77, v77, v253
    v_mul_f32 v78, v78, v253
    v_mul_f32 v79, v79, v253
    v_mfma_f32_32x32x16_bf16 v[48:63], v[148:151], v[224:227], v[48:63]
    v_mul_f32 v128, v128, v253
    v_mul_f32 v129, v129, v253
    v_mul_f32 v130, v130, v253
    v_mul_f32 v131, v131, v253
    v_mul_f32 v132, v132, v253
    s_waitcnt vmcnt(4)
    v_mfma_f32_32x32x16_bf16 v[32:47], v[152:155], v[228:231], v[32:47]
    v_mul_f32 v133, v133, v253
    v_mul_f32 v134, v134, v253
    v_mul_f32 v135, v135, v253
    v_mul_f32 v136, v136, v253
    v_mul_f32 v137, v137, v253
    v_mul_f32 v138, v138, v253
    v_mfma_f32_32x32x16_bf16 v[48:63], v[156:159], v[228:231], v[48:63]
    v_mul_f32 v139, v139, v253
    v_mul_f32 v140, v140, v253
    v_mul_f32 v141, v141, v253
    v_mul_f32 v142, v142, v253
    v_mul_f32 v143, v143, v253
    s_nop 0
    s_branch L_o_join
L_kv:
    v_lshrrev_b32 v1, 6, v0
    v_and_b32 v0, 63, v0
    v_readfirstlane_b32 s60, v1
    s_and_b32 s61, s2, 7
    s_lshr_b32 s62, s2, 3
    s_mov_b32 s70, 0x3fb8aa3b
    s_and_b32 s48, s48, 0xffffff00
    s_mov_b32 s50, L_code_end-gated_mix__linear_kernel_hedgehog__glu_gated_swiglu__prompt_kernel
    s_mov_b32 s51, 0x20000
    s_and_b32 s63, s62, 7
    s_lshl_b32 s63, s63, 3
    s_add_u32 s63, s63, s60
    s_mul_i32 s63, s63, 768
    v_min_u32 v2, 5, v0
    v_lshlrev_b32 v2, 7, v2
    buffer_load_dword v16, v2, s[48:51], s63 offen
    v_mov_b32 v18, 1
    v_cmp_eq_u32 vcc, 0, v0
    v_mov_b32 v17, 0x4000000
    v_lshlrev_b32 v1, 4, v0
    s_lshl_b32 s69, s60, 10
    v_cndmask_b32 v17, v17, v0, vcc
    s_and_b32 s63, s60, 1
    s_lshl_b32 s63, s63, 2
    v_lshrrev_b32 v28, 4, v0
    v_add_u32 v28, s63, v28
    v_and_b32 v29, 7, v0
    v_xor_b32 v28, v28, v29
    v_lshlrev_b32 v28, 4, v28
    v_lshrrev_b32 v29, 3, v0
    v_mul_u32_u24 v29, 896, v29
    v_add_u32 v4, v28, v29
    s_lshr_b32 s75, s61, 2
    s_xor_b32 s75, s75, s61
    s_and_b32 s75, s75, 1
    s_mul_i32 s75, s75, 4
    s_setprio 1
    s_lshr_b32 s72, s61, 2
    s_lshl_b32 s72, s72, 2
    s_and_b32 s63, s62, 3
    s_add_u32 s72, s72, s63
    s_and_b32 s73, s61, 3
    s_lshl_b32 s73, s73, 1
    s_sub_u32 s63, s62, 20
    s_lshr_b32 s63, s63, 2
    s_add_u32 s73, s73, s63
    s_lshl_b32 s64, s73, 1
    s_add_u32 s64, s64, s72
    s_mul_i32 s64, s64, 2
    s_add_u32 s64, s64, s60
    s_and_b32 s64, s64, 7
    s_lshl_b32 s69, s64, 10
    s_mul_i32 s67, s64, 10752
    s_mul_i32 s63, s73, 112
    s_add_u32 s67, s67, s63
    s_mul_i32 s68, s72, 229376
    s_mul_i32 s63, s64, 7168
    s_add_u32 s68, s68, s63
    v_lshrrev_b32 v28, 4, v0
    v_lshlrev_b32 v29, 2, v28
    v_and_b32 v30, 15, v0
    v_xor_b32 v29, v29, v30
    v_mul_u32_u24 v28, 2688, v28
    v_lshrrev_b32 v30, 3, v29
    v_mul_u32_u24 v30, 896, v30
    v_and_b32 v29, 7, v29
    v_cmp_eq_u32 vcc, 7, v29
    v_lshl_add_u32 v29, v29, 4, v30
    v_add_u32 v29, 0x380, v29
    v_add_u32 v2, v29, v28
    v_mov_b32 v29, 0x4000000
    v_cndmask_b32 v2, v2, v29, vcc
    s_mov_b32 s30, 0x1c0000
    s_mov_b32 s31, 0x20000
    s_mov_b32 s34, 0x126000
    s_mov_b32 s35, 0x20000
    s_mov_b32 s42, 0xa00000
    s_mov_b32 s43, 0x20000
    s_mov_b32 s58, 0x100
    s_mov_b32 s59, 0x20000
    s_waitcnt lgkmcnt(0)
    s_mov_b64 s[28:29], s[4:5]
    s_mov_b64 s[32:33], s[6:7]
    s_mov_b64 s[40:41], s[26:27]
    s_mov_b64 s[56:57], s[24:25]
    s_mov_b32 s24, s75
    s_mul_i32 s25, s24, 172032
    s_add_u32 s25, s25, s67
    s_lshl_b32 s26, s24, 7
    s_add_u32 s26, s26, s68
    s_add_u32 m0, s69, 0
    s_add_u32 s74, s25, 0
    buffer_load_dwordx4 v2, s[32:35], s74 offen lds
    s_add_u32 m0, s69, 16384
    s_add_u32 s74, s26, 0
    buffer_load_dwordx4 v4, s[28:31], s74 offen lds
    s_add_u32 m0, s69, 32768
    s_add_u32 s74, s26, 114688
    buffer_load_dwordx4 v4, s[28:31], s74 offen lds
    s_add_u32 m0, s69, 8192
    s_add_u32 s74, s25, 86016
    buffer_load_dwordx4 v2, s[32:35], s74 offen lds
    s_add_u32 m0, s69, 24576
    s_add_u32 s74, s26, 57344
    buffer_load_dwordx4 v4, s[28:31], s74 offen lds
    s_add_u32 m0, s69, 40960
    s_add_u32 s74, s26, 172032
    buffer_load_dwordx4 v4, s[28:31], s74 offen lds
    s_mov_b32 s36, s8
    s_mov_b32 s37, s9
    s_mov_b32 s38, 0x6200
    s_mov_b32 s39, 0x20000
    s_mul_i32 s71, s73, 3136
    s_add_u32 s71, s71, s69
    s_cmp_lt_u32 s69, 4096
    s_cselect_b32 s71, s71, 0x4000000
    s_and_b32 s64, s60, 3
    s_lshl_b32 s64, s64, 13
    s_lshr_b32 s66, s60, 2
    v_bfe_u32 v28, v0, 1, 3
    v_lshrrev_b32 v29, 5, v0
    v_xor_b32 v28, v28, v29
    v_lshlrev_b32 v28, 4, v28
    v_and_b32 v29, 31, v0
    v_lshl_add_u32 v6, v29, 7, v28
    v_add_u32 v6, s64, v6
    v_xor_b32 v7, 32, v6
    v_xor_b32 v8, 64, v6
    v_xor_b32 v9, 96, v6
    v_bfe_u32 v28, v0, 2, 2
    v_bfe_u32 v29, v0, 4, 1
    v_and_b32 v30, 3, v0
    v_lshl_add_u32 v29, v29, 2, v30
    v_cmp_eq_u32 vcc, 7, v29
    v_lshlrev_b32 v30, 3, v29
    v_lshrrev_b32 v31, 5, v0
    v_lshl_add_u32 v31, v31, 3, v28
    v_lshlrev_b32 v31, 8, v31
    v_lshlrev_b32 v28, 6, v28
    s_mul_i32 s63, s66, 56
    v_add_u32 v3, s63, v30
    s_lshl_b32 s63, s66, 3
    s_sub_u32 s63, 120, s63
    v_mov_b32 v30, s63
    v_cndmask_b32 v3, v3, v30, vcc
    v_add_u32 v5, 0x80, v3
    v_and_b32 v30, 31, v0
    v_cmp_eq_u32 vcc, 28, v30
    s_nop 1
    v_cndmask_b32_e64 v200, 0, 1.0, vcc
    v_mov_b32 v201, v200
    v_mov_b32 v202, v200
    v_mov_b32 v203, v200
    v_mov_b32 v204, v200
    v_mov_b32 v205, v200
    v_mov_b32 v206, v200
    v_mov_b32 v207, v200
    v_mov_b32 v208, v200
    v_mov_b32 v209, v200
    v_mov_b32 v210, v200
    v_mov_b32 v211, v200
    v_mov_b32 v212, v200
    v_mov_b32 v213, v200
    v_mov_b32 v214, v200
    v_mov_b32 v215, v200
    v_xor_b32 v3, v3, v28
    v_xor_b32 v5, v5, v28
    v_add_u32 v3, v3, v31
    v_add_u32 v5, v5, v31
    s_barrier
    s_add_u32 m0, s69, 147456
    s_add_u32 s74, s71, 0
    buffer_load_dwordx4 v1, s[36:39], s74 offen lds
    s_add_u32 s24, s24, 1
    s_cmp_eq_u32 s24, 7
    s_cselect_b32 s24, 0, s24
    s_mul_i32 s25, s24, 172032
    s_add_u32 s25, s25, s67
    s_lshl_b32 s26, s24, 7
    s_add_u32 s26, s26, s68
    s_add_u32 m0, s69, 98304
    s_add_u32 s74, s25, 0
    buffer_load_dwordx4 v2, s[32:35], s74 offen lds
    s_add_u32 m0, s69, 114688
    s_add_u32 s74, s26, 0
    buffer_load_dwordx4 v4, s[28:31], s74 offen lds
    s_add_u32 m0, s69, 131072
    s_add_u32 s74, s26, 114688
    buffer_load_dwordx4 v4, s[28:31], s74 offen lds
    s_add_u32 m0, s69, 106496
    s_add_u32 s74, s25, 86016
    buffer_load_dwordx4 v2, s[32:35], s74 offen lds
    s_add_u32 m0, s69, 122880
    s_add_u32 s74, s26, 57344
    buffer_load_dwordx4 v4, s[28:31], s74 offen lds
    s_add_u32 m0, s69, 139264
    s_add_u32 s74, s26, 172032
    buffer_load_dwordx4 v4, s[28:31], s74 offen lds
    s_waitcnt vmcnt(7)
    s_barrier
    ds_read_b64_tr_b16 v[32:33], v3 offset:0
    ds_read_b64_tr_b16 v[34:35], v3 offset:1024
    ds_read_b128 v[48:51], v6 offset:16384
    ds_read_b128 v[52:55], v6 offset:20480
    ds_read_b64_tr_b16 v[36:37], v5 offset:0
    ds_read_b64_tr_b16 v[38:39], v5 offset:1024
    s_waitcnt lgkmcnt(3)
    v_mfma_f32_32x32x16_bf16 v[152:167], v[32:35], v[48:51], 0
    ds_read_b64_tr_b16 v[40:41], v3 offset:4096
    ds_read_b64_tr_b16 v[42:43], v3 offset:5120
    s_mov_b32 s44, s18
    s_mov_b32 s45, s19
    s_mov_b32 s46, 0x188000
    s_mov_b32 s47, 0x20000
    s_mov_b32 s48, s10
    s_mov_b32 s49, s11
    s_mov_b32 s50, 0x62000
    s_waitcnt lgkmcnt(4)
    v_mfma_f32_32x32x16_bf16 v[168:183], v[32:35], v[52:55], 0
    ds_read_b128 v[56:59], v7 offset:16384
    ds_read_b128 v[60:63], v7 offset:20480
    s_add_u32 s24, s24, 1
    s_cmp_eq_u32 s24, 7
    s_cselect_b32 s24, 0, s24
    s_mul_i32 s25, s24, 172032
    s_add_u32 s25, s25, s67
    s_lshl_b32 s26, s24, 7
    s_add_u32 s26, s26, s68
    s_mov_b32 s51, 0x20000
    s_mov_b32 s52, s22
    s_mov_b32 s53, s23
    s_mov_b32 s54, 0x1c0000
    s_mov_b32 s55, 0x20000
    s_lshr_b32 s18, s60, 2
    s_and_b32 s19, s60, 3
    s_waitcnt lgkmcnt(4)
    v_mfma_f32_32x32x16_bf16 v[184:199], v[48:51], v[36:39], v[200:215]
    ds_read_b64_tr_b16 v[44:45], v5 offset:4096
    ds_read_b64_tr_b16 v[46:47], v5 offset:5120
    s_lshl_b32 s22, s73, 1
    s_add_u32 s22, s22, s18
    v_mul_u32_u24 v250, 12, v0
    v_lshrrev_b32 v251, 3, v0
    v_mul_u32_u24 v251, 7168, v251
    v_lshl_add_u32 v251, v0, 7, v251
    v_cmp_gt_u32 vcc, 14, v0
    v_mfma_f32_32x32x16_bf16 v[200:215], v[52:55], v[36:39], v[200:215]
    s_add_u32 m0, s69, 49152
    s_add_u32 s74, s25, 0
    buffer_load_dwordx4 v2, s[32:35], s74 offen lds
    v_mov_b32 v28, 0x4000000
    v_cndmask_b32 v251, v28, v251, vcc
    s_lshl_b32 s63, s73, 2
    s_add_u32 s63, s63, s19
    s_lshl_b32 s76, s63, 4
    s_add_u32 s76, s76, s72
    s_lshl_b32 s76, s76, 10
    s_waitcnt lgkmcnt(3)
    v_mfma_f32_32x32x16_bf16 v[152:167], v[40:43], v[56:59], v[152:167]
    ds_read_b64_tr_b16 v[32:33], v3 offset:8192
    ds_read_b64_tr_b16 v[34:35], v3 offset:9216
    s_add_u32 s76, s76, 0x900000
    s_add_u32 s77, s76, 8192
    s_mul_i32 s65, s18, 1568
    s_add_u32 s65, s65, 147456
    v_and_b32 v28, 31, v0
    v_subrev_u32 v29, 2, v28
    v_cmp_gt_u32 vcc, 28, v28
    s_waitcnt lgkmcnt(4)
    v_mfma_f32_32x32x16_bf16 v[168:183], v[40:43], v[60:63], v[168:183]
    ds_read_b128 v[48:51], v8 offset:16384
    ds_read_b128 v[52:55], v8 offset:20480
    s_add_u32 m0, s69, 65536
    s_add_u32 s74, s26, 0
    buffer_load_dwordx4 v4, s[28:31], s74 offen lds
    v_cndmask_b32 v29, v29, v28, vcc
    v_lshlrev_b32 v29, 1, v29
    v_lshrrev_b32 v25, 5, v0
    v_mul_u32_u24 v25, 224, v25
    v_add3_u32 v25, v25, v29, s65
    v_and_b32 v28, 26, v28
    v_cmp_eq_u32 vcc, 26, v28
    s_waitcnt lgkmcnt(4)
    v_mfma_f32_32x32x16_bf16 v[184:199], v[56:59], v[44:47], v[184:199]
    ds_read_b64_tr_b16 v[36:37], v5 offset:8192
    ds_read_b64_tr_b16 v[38:39], v5 offset:9216
    s_add_u32 m0, s69, 81920
    s_add_u32 s74, s26, 114688
    buffer_load_dwordx4 v4, s[28:31], s74 offen lds
    v_cndmask_b32_e64 v26, -1, 0, vcc
    v_cmp_lt_u32 vcc, 31, v0
    s_nop 1
    v_cndmask_b32_e64 v27, v26, 0, vcc
    s_mul_i32 s63, s62, 37
    s_lshr_b32 s63, s63, 8
    s_mul_i32 s82, s63, 7
    s_sub_u32 s82, s62, s82
    v_mfma_f32_32x32x16_bf16 v[200:215], v[60:63], v[44:47], v[200:215]
    s_add_u32 m0, s69, 57344
    s_add_u32 s74, s25, 86016
    buffer_load_dwordx4 v2, s[32:35], s74 offen lds
    s_mul_i32 s88, s82, 1
    s_mul_i32 s64, s63, 0
    s_add_u32 s88, s88, s64
    s_add_u32 s88, s88, s60
    s_and_b32 s88, s88, 7
    s_mul_i32 s64, s61, 3
    s_add_u32 s64, s64, s63
    s_waitcnt lgkmcnt(3)
    v_mfma_f32_32x32x16_bf16 v[152:167], v[32:35], v[48:51], v[152:167]
    ds_read_b64_tr_b16 v[40:41], v3 offset:12288
    ds_read_b64_tr_b16 v[42:43], v3 offset:13312
    s_add_u32 m0, s69, 73728
    s_add_u32 s74, s26, 57344
    buffer_load_dwordx4 v4, s[28:31], s74 offen lds
    s_sub_u32 s65, s64, 12
    s_cmp_eq_u32 s63, 3
    s_cselect_b32 s65, s61, s65
    s_cselect_b32 s64, 20, s64
    s_mul_i32 s80, s65, 6
    s_add_u32 s80, s80, 2
    s_lshl_b32 s66, s65, 1
    s_waitcnt lgkmcnt(4)
    v_mfma_f32_32x32x16_bf16 v[168:183], v[32:35], v[52:55], v[168:183]
    ds_read_b128 v[56:59], v9 offset:16384
    ds_read_b128 v[60:63], v9 offset:20480
    s_add_u32 s66, s66, 40
    s_cmp_ge_i32 s65, 10
    s_cselect_b32 s80, s66, s80
    s_lshr_b32 s65, s64, 1
    s_mul_i32 s65, s65, 6
    s_and_b32 s66, s64, 1
    s_add_u32 s65, s65, s66
    s_waitcnt lgkmcnt(4)
    v_mfma_f32_32x32x16_bf16 v[184:199], v[48:51], v[36:39], v[184:199]
    ds_read_b64_tr_b16 v[44:45], v5 offset:12288
    ds_read_b64_tr_b16 v[46:47], v5 offset:13312
    s_add_u32 m0, s69, 90112
    s_add_u32 s74, s26, 172032
    buffer_load_dwordx4 v4, s[28:31], s74 offen lds
    s_cmp_lt_u32 s64, 20
    s_cselect_b32 s80, s65, s80
    s_cselect_b32 s66, 4, 1
    s_add_u32 s81, s80, s66
    s_mul_i32 s4, s60, 6144
    s_lshl_b32 s27, s60, 13
    s_lshl_b32 s63, s82, 7
    v_mfma_f32_32x32x16_bf16 v[200:215], v[52:55], v[36:39], v[200:215]
    s_mul_i32 s5, s88, 200704
    s_add_u32 s5, s5, s63
    s_mul_i32 s10, s88, 50176
    s_add_u32 s10, s10, s63
    s_cmp_ge_u32 s60, 4
    s_cselect_b32 s23, s81, s80
    s_waitcnt lgkmcnt(0)
    v_mfma_f32_32x32x16_bf16 v[152:167], v[40:43], v[56:59], v[152:167]
    s_waitcnt vmcnt(6)
    s_barrier
    v_mfma_f32_32x32x16_bf16 v[168:183], v[40:43], v[60:63], v[168:183]
    v_add_u32 v3, 0x18000, v3
    v_add_u32 v5, 0x18000, v5
    v_add_u32 v6, 0x18000, v6
    v_add_u32 v7, 0x18000, v7
    v_add_u32 v8, 0x18000, v8
    v_add_u32 v9, 0x18000, v9
    ds_read_b64_tr_b16 v[32:33], v3 offset:0
    ds_read_b64_tr_b16 v[34:35], v3 offset:1024
    ds_read_b128 v[48:51], v6 offset:16384
    v_mfma_f32_32x32x16_bf16 v[184:199], v[56:59], v[44:47], v[184:199]
    ds_read_b128 v[52:55], v6 offset:20480
    ds_read_b64_tr_b16 v[36:37], v5 offset:0
    ds_read_b64_tr_b16 v[38:39], v5 offset:1024
    s_mul_i32 s23, s23, 28672
    s_add_u32 s23, s23, s63
    s_and_b32 s63, s60, 3
    s_mul_i32 s63, s63, 7168
    v_mfma_f32_32x32x16_bf16 v[200:215], v[60:63], v[44:47], v[200:215]
    s_add_u32 s24, s24, 1
    s_cmp_eq_u32 s24, 7
    s_cselect_b32 s24, 0, s24
    s_mul_i32 s25, s24, 172032
    s_add_u32 s25, s25, s67
    s_lshl_b32 s26, s24, 7
    s_add_u32 s26, s26, s68
    s_add_u32 s23, s23, s63
    s_mul_i32 s63, s88, 14
    s_mul_i32 s64, s80, 112
    s_add_u32 s64, s64, s63
    s_waitcnt lgkmcnt(3)
    v_mfma_f32_32x32x16_bf16 v[152:167], v[32:35], v[48:51], v[152:167]
    ds_read_b64_tr_b16 v[40:41], v3 offset:4096
    ds_read_b64_tr_b16 v[42:43], v3 offset:5120
    s_lshl_b32 s83, s64, 10
    s_mul_i32 s11, s80, 1792
    s_add_u32 s11, s11, 0x990000
    s_waitcnt lgkmcnt(4)
    v_mfma_f32_32x32x16_bf16 v[168:183], v[32:35], v[52:55], v[168:183]
    ds_read_b128 v[56:59], v7 offset:16384
    ds_read_b128 v[60:63], v7 offset:20480
    s_lshl_b32 s64, s80, 3
    s_add_u32 s64, s64, s88
    s_lshl_b32 s85, s64, 12
    s_add_u32 s85, s85, 0x700000
    s_waitcnt lgkmcnt(4)
    v_mfma_f32_32x32x16_bf16 v[184:199], v[48:51], v[36:39], v[184:199]
    ds_read_b64_tr_b16 v[44:45], v5 offset:4096
    ds_read_b64_tr_b16 v[46:47], v5 offset:5120
    s_add_u32 m0, s69, 0
    s_add_u32 s74, s25, 0
    buffer_load_dwordx4 v2, s[32:35], s74 offen lds
    s_mul_i32 s64, s81, 112
    s_add_u32 s64, s64, s63
    s_lshl_b32 s84, s64, 10
    v_mfma_f32_32x32x16_bf16 v[200:215], v[52:55], v[36:39], v[200:215]
    s_add_u32 m0, s69, 16384
    s_add_u32 s74, s26, 0
    buffer_load_dwordx4 v4, s[28:31], s74 offen lds
    s_mul_i32 s12, s81, 1792
    s_add_u32 s12, s12, 0x990000
    s_lshl_b32 s64, s81, 3
    s_add_u32 s64, s64, s88
    s_lshl_b32 s86, s64, 12
    s_add_u32 s86, s86, 0x700000
    v_lshlrev_b32 v13, 3, v0
    s_waitcnt lgkmcnt(3)
    v_mfma_f32_32x32x16_bf16 v[152:167], v[40:43], v[56:59], v[152:167]
    ds_read_b64_tr_b16 v[32:33], v3 offset:8192
    ds_read_b64_tr_b16 v[34:35], v3 offset:9216
    v_min_u32 v13, 13, v13
    v_add_u32 v13, s63, v13
    s_lshl_b32 s63, s88, 7
    s_add_u32 s13, s63, 0x9ac000
    s_waitcnt lgkmcnt(4)
    v_mfma_f32_32x32x16_bf16 v[168:183], v[40:43], v[60:63], v[168:183]
    ds_read_b128 v[48:51], v8 offset:16384
    ds_read_b128 v[52:55], v8 offset:20480
    s_add_u32 m0, s69, 32768
    s_add_u32 s74, s26, 114688
    buffer_load_dwordx4 v4, s[28:31], s74 offen lds
    s_lshl_b32 s63, s80, 10
    s_lshl_b32 s64, s81, 10
    v_mov_b32 v14, s64
    v_mov_b32 v28, s63
    s_waitcnt lgkmcnt(4)
    v_mfma_f32_32x32x16_bf16 v[184:199], v[56:59], v[44:47], v[184:199]
    ds_read_b64_tr_b16 v[36:37], v5 offset:8192
    ds_read_b64_tr_b16 v[38:39], v5 offset:9216
    v_cmp_eq_u32 vcc, 0, v0
    v_lshrrev_b32 v13, 3, v13
    v_lshlrev_b32 v13, 7, v13
    v_mfma_f32_32x32x16_bf16 v[200:215], v[60:63], v[44:47], v[200:215]
    s_add_u32 m0, s69, 8192
    s_add_u32 s74, s25, 86016
    buffer_load_dwordx4 v2, s[32:35], s74 offen lds
    v_cndmask_b32 v14, v14, v28, vcc
    v_bfe_u32 v28, v0, 4, 1
    v_lshlrev_b32 v28, 6, v28
    v_and_b32 v29, 0x70, v1
    s_waitcnt lgkmcnt(3)
    v_mfma_f32_32x32x16_bf16 v[152:167], v[32:35], v[48:51], v[152:167]
    ds_read_b64_tr_b16 v[40:41], v3 offset:12288
    ds_read_b64_tr_b16 v[42:43], v3 offset:13312
    s_add_u32 m0, s69, 24576
    s_add_u32 s74, s26, 57344
    buffer_load_dwordx4 v4, s[28:31], s74 offen lds
    v_xor_b32 v28, v28, v29
    v_lshrrev_b32 v29, 3, v0
    v_mul_u32_u24 v29, 896, v29
    s_waitcnt lgkmcnt(4)
    v_mfma_f32_32x32x16_bf16 v[168:183], v[32:35], v[52:55], v[168:183]
    ds_read_b128 v[56:59], v9 offset:16384
    ds_read_b128 v[60:63], v9 offset:20480
    v_add_u32 v10, v28, v29
    v_bfe_u32 v28, v0, 2, 2
    v_lshrrev_b32 v29, 5, v0
    v_lshl_or_b32 v15, v29, 26, v10
    s_waitcnt lgkmcnt(4)
    v_mfma_f32_32x32x16_bf16 v[184:199], v[48:51], v[36:39], v[184:199]
    ds_read_b64_tr_b16 v[44:45], v5 offset:12288
    ds_read_b64_tr_b16 v[46:47], v5 offset:13312
    s_add_u32 m0, s69, 40960
    s_add_u32 s74, s26, 172032
    buffer_load_dwordx4 v4, s[28:31], s74 offen lds
    v_lshl_add_u32 v29, v29, 2, v28
    v_lshlrev_b32 v29, 7, v29
    v_bfe_u32 v28, v0, 3, 1
    v_mfma_f32_32x32x16_bf16 v[200:215], v[52:55], v[36:39], v[200:215]
    v_lshl_add_u32 v29, v28, 6, v29
    v_bfe_u32 v28, v0, 4, 1
    v_lshl_add_u32 v29, v28, 5, v29
    v_and_b32 v28, 1, v0
    v_lshl_add_u32 v29, v28, 4, v29
    v_bfe_u32 v28, v0, 1, 1
    v_lshl_add_u32 v29, v28, 3, v29
    s_waitcnt lgkmcnt(0)
    v_mfma_f32_32x32x16_bf16 v[152:167], v[40:43], v[56:59], v[152:167]
    s_waitcnt vmcnt(6)
    s_barrier
    v_mfma_f32_32x32x16_bf16 v[168:183], v[40:43], v[60:63], v[168:183]
    v_add_u32 v3, 0xffff4000, v3
    v_add_u32 v5, 0xffff4000, v5
    v_add_u32 v6, 0xffff4000, v6
    v_add_u32 v7, 0xffff4000, v7
    v_add_u32 v8, 0xffff4000, v8
    v_add_u32 v9, 0xffff4000, v9
    ds_read_b64_tr_b16 v[32:33], v3 offset:0
    ds_read_b64_tr_b16 v[34:35], v3 offset:1024
    ds_read_b128 v[48:51], v6 offset:16384
    v_mfma_f32_32x32x16_bf16 v[184:199], v[56:59], v[44:47], v[184:199]
    ds_read_b128 v[52:55], v6 offset:20480
    ds_read_b64_tr_b16 v[36:37], v5 offset:0
    ds_read_b64_tr_b16 v[38:39], v5 offset:1024
    v_add_u32 v11, s4, v29
    v_xor_b32 v12, 64, v11
    v_mfma_f32_32x32x16_bf16 v[200:215], v[60:63], v[44:47], v[200:215]
    s_add_u32 s24, s24, 1
    s_cmp_eq_u32 s24, 7
    s_cselect_b32 s24, 0, s24
    s_mul_i32 s25, s24, 172032
    s_add_u32 s25, s25, s67
    s_lshl_b32 s26, s24, 7
    s_add_u32 s26, s26, s68
    v_cmp_gt_u32 vcc, 3, v0
    v_mov_b32 v28, 0x4000000
    s_waitcnt lgkmcnt(3)
    v_mfma_f32_32x32x16_bf16 v[152:167], v[32:35], v[48:51], v[152:167]
    ds_read_b64_tr_b16 v[40:41], v3 offset:4096
    ds_read_b64_tr_b16 v[42:43], v3 offset:5120
    v_cndmask_b32 v13, v28, v13, vcc
    v_cmp_gt_u32 vcc, 2, v0
    s_waitcnt lgkmcnt(4)
    v_mfma_f32_32x32x16_bf16 v[168:183], v[32:35], v[52:55], v[168:183]
    ds_read_b128 v[56:59], v7 offset:16384
    ds_read_b128 v[60:63], v7 offset:20480
    v_mov_b32 v28, 0x4000000
    s_waitcnt lgkmcnt(4)
    v_mfma_f32_32x32x16_bf16 v[184:199], v[48:51], v[36:39], v[184:199]
    ds_read_b64_tr_b16 v[44:45], v5 offset:4096
    ds_read_b64_tr_b16 v[46:47], v5 offset:5120
    s_add_u32 m0, s69, 98304
    s_add_u32 s74, s25, 0
    buffer_load_dwordx4 v2, s[32:35], s74 offen lds
    v_cndmask_b32 v14, v28, v14, vcc
    s_lshl_b32 s63, s18, 15
    v_mfma_f32_32x32x16_bf16 v[200:215], v[52:55], v[36:39], v[200:215]
    s_add_u32 m0, s69, 114688
    s_add_u32 s74, s26, 0
    buffer_load_dwordx4 v4, s[28:31], s74 offen lds
    s_lshl_b32 s64, s19, 12
    s_add_u32 s63, s63, s64
    s_add_u32 s63, s63, 98304
    v_bfe_u32 v28, v0, 1, 2
    s_waitcnt lgkmcnt(3)
    v_mfma_f32_32x32x16_bf16 v[152:167], v[40:43], v[56:59], v[152:167]
    ds_read_b64_tr_b16 v[32:33], v3 offset:8192
    ds_read_b64_tr_b16 v[34:35], v3 offset:9216
    v_lshrrev_b32 v29, 5, v0
    s_waitcnt lgkmcnt(4)
    v_mfma_f32_32x32x16_bf16 v[168:183], v[40:43], v[60:63], v[168:183]
    ds_read_b128 v[48:51], v8 offset:16384
    ds_read_b128 v[52:55], v8 offset:20480
    s_add_u32 m0, s69, 131072
    s_add_u32 s74, s26, 114688
    buffer_load_dwordx4 v4, s[28:31], s74 offen lds
    v_lshlrev_b32 v30, 1, v29
    v_xor_b32 v28, v28, v30
    s_waitcnt lgkmcnt(4)
    v_mfma_f32_32x32x16_bf16 v[184:199], v[56:59], v[44:47], v[184:199]
    ds_read_b64_tr_b16 v[36:37], v5 offset:8192
    ds_read_b64_tr_b16 v[38:39], v5 offset:9216
    v_lshlrev_b32 v28, 4, v28
    v_and_b32 v31, 31, v0
    v_mfma_f32_32x32x16_bf16 v[200:215], v[60:63], v[44:47], v[200:215]
    s_add_u32 m0, s69, 106496
    s_add_u32 s74, s25, 86016
    buffer_load_dwordx4 v2, s[32:35], s74 offen lds
    v_lshl_add_u32 v28, v31, 6, v28
    v_add_u32 v248, s63, v28
    s_waitcnt lgkmcnt(3)
    v_mfma_f32_32x32x16_bf16 v[152:167], v[32:35], v[48:51], v[152:167]
    ds_read_b64_tr_b16 v[40:41], v3 offset:12288
    ds_read_b64_tr_b16 v[42:43], v3 offset:13312
    s_add_u32 m0, s69, 122880
    s_add_u32 s74, s26, 57344
    buffer_load_dwordx4 v4, s[28:31], s74 offen lds
    v_xor_b32 v249, 16, v248
    s_waitcnt lgkmcnt(4)
    v_mfma_f32_32x32x16_bf16 v[168:183], v[32:35], v[52:55], v[168:183]
    ds_read_b128 v[56:59], v9 offset:16384
    ds_read_b128 v[60:63], v9 offset:20480
    s_lshl_b32 s63, s19, 14
    s_add_u32 s63, s63, 98304
    s_waitcnt lgkmcnt(4)
    v_mfma_f32_32x32x16_bf16 v[184:199], v[48:51], v[36:39], v[184:199]
    ds_read_b64_tr_b16 v[44:45], v5 offset:12288
    ds_read_b64_tr_b16 v[46:47], v5 offset:13312
    s_add_u32 m0, s69, 139264
    s_add_u32 s74, s26, 172032
    buffer_load_dwordx4 v4, s[28:31], s74 offen lds
    v_bfe_u32 v28, v0, 3, 1
    v_add_u32 v30, v30, v28
    v_mfma_f32_32x32x16_bf16 v[200:215], v[52:55], v[36:39], v[200:215]
    v_bfe_u32 v28, v0, 4, 1
    v_xor_b32 v30, v30, v28
    v_and_b32 v28, 1, v0
    s_waitcnt lgkmcnt(0)
    v_mfma_f32_32x32x16_bf16 v[152:167], v[40:43], v[56:59], v[152:167]
    s_waitcnt vmcnt(6)
    s_barrier
    v_mfma_f32_32x32x16_bf16 v[168:183], v[40:43], v[60:63], v[168:183]
    v_add_u32 v3, 0xffff4000, v3
    v_add_u32 v5, 0xffff4000, v5
    v_add_u32 v6, 0xffff4000, v6
    v_add_u32 v7, 0xffff4000, v7
    v_add_u32 v8, 0xffff4000, v8
    v_add_u32 v9, 0xffff4000, v9
    ds_read_b64_tr_b16 v[32:33], v3 offset:0
    ds_read_b64_tr_b16 v[34:35], v3 offset:1024
    ds_read_b128 v[48:51], v6 offset:16384
    v_mfma_f32_32x32x16_bf16 v[184:199], v[56:59], v[44:47], v[184:199]
    ds_read_b128 v[52:55], v6 offset:20480
    ds_read_b64_tr_b16 v[36:37], v5 offset:0
    ds_read_b64_tr_b16 v[38:39], v5 offset:1024
    v_lshlrev_b32 v28, 1, v28
    v_xor_b32 v30, v30, v28
    v_mfma_f32_32x32x16_bf16 v[200:215], v[60:63], v[44:47], v[200:215]
    s_add_u32 s24, s24, 1
    s_cmp_eq_u32 s24, 7
    s_cselect_b32 s24, 0, s24
    s_mul_i32 s25, s24, 172032
    s_add_u32 s25, s25, s67
    s_lshl_b32 s26, s24, 7
    s_add_u32 s26, s26, s68
    v_lshlrev_b32 v30, 4, v30
    v_bfe_u32 v28, v0, 1, 1
    s_waitcnt lgkmcnt(3)
    v_mfma_f32_32x32x16_bf16 v[152:167], v[32:35], v[48:51], v[152:167]
    ds_read_b64_tr_b16 v[40:41], v3 offset:4096
    ds_read_b64_tr_b16 v[42:43], v3 offset:5120
    v_lshl_add_u32 v30, v28, 3, v30
    v_bfe_u32 v28, v0, 2, 2
    s_waitcnt lgkmcnt(4)
    v_mfma_f32_32x32x16_bf16 v[168:183], v[32:35], v[52:55], v[168:183]
    ds_read_b128 v[56:59], v7 offset:16384
    ds_read_b128 v[60:63], v7 offset:20480
    v_lshl_add_u32 v28, v29, 2, v28
    v_lshl_add_u32 v30, v28, 6, v30
    s_waitcnt lgkmcnt(4)
    v_mfma_f32_32x32x16_bf16 v[184:199], v[48:51], v[36:39], v[184:199]
    ds_read_b64_tr_b16 v[44:45], v5 offset:4096
    ds_read_b64_tr_b16 v[46:47], v5 offset:5120
    s_add_u32 m0, s69, 49152
    s_add_u32 s74, s25, 0
    buffer_load_dwordx4 v2, s[32:35], s74 offen lds
    v_add_u32 v252, s63, v30
    v_add_u32 v254, s4, v1
    v_mfma_f32_32x32x16_bf16 v[200:215], v[52:55], v[36:39], v[200:215]
    s_add_u32 m0, s69, 65536
    s_add_u32 s74, s26, 0
    buffer_load_dwordx4 v4, s[28:31], s74 offen lds
    s_lshr_b32 s63, s19, 1
    s_mul_i32 s63, s63, 24576
    v_add_u32 v255, s63, v1
    s_waitcnt lgkmcnt(3)
    v_mfma_f32_32x32x16_bf16 v[152:167], v[40:43], v[56:59], v[152:167]
    ds_read_b64_tr_b16 v[32:33], v3 offset:8192
    ds_read_b64_tr_b16 v[34:35], v3 offset:9216
    ds_read_u16 v216, v25 offset:0
    ds_read_u16 v217, v25 offset:56
    s_waitcnt lgkmcnt(6)
    v_mfma_f32_32x32x16_bf16 v[168:183], v[40:43], v[60:63], v[168:183]
    ds_read_b128 v[48:51], v8 offset:16384
    ds_read_b128 v[52:55], v8 offset:20480
    s_add_u32 m0, s69, 81920
    s_add_u32 s74, s26, 114688
    buffer_load_dwordx4 v4, s[28:31], s74 offen lds
    ds_read_u16 v218, v25 offset:112
    ds_read_u16 v219, v25 offset:168
    s_waitcnt lgkmcnt(8)
    v_mfma_f32_32x32x16_bf16 v[184:199], v[56:59], v[44:47], v[184:199]
    ds_read_b64_tr_b16 v[36:37], v5 offset:8192
    ds_read_b64_tr_b16 v[38:39], v5 offset:9216
    v_mfma_f32_32x32x16_bf16 v[200:215], v[60:63], v[44:47], v[200:215]
    s_add_u32 m0, s69, 57344
    s_add_u32 s74, s25, 86016
    buffer_load_dwordx4 v2, s[32:35], s74 offen lds
    ds_read_u16 v220, v25 offset:448
    ds_read_u16 v221, v25 offset:504
    ds_read_u16 v222, v25 offset:560
    s_waitcnt lgkmcnt(8)
    v_mfma_f32_32x32x16_bf16 v[152:167], v[32:35], v[48:51], v[152:167]
    ds_read_b64_tr_b16 v[40:41], v3 offset:12288
    ds_read_b64_tr_b16 v[42:43], v3 offset:13312
    s_add_u32 m0, s69, 73728
    s_add_u32 s74, s26, 57344
    buffer_load_dwordx4 v4, s[28:31], s74 offen lds
    ds_read_u16 v223, v25 offset:616
    ds_read_u16 v224, v25 offset:896
    s_waitcnt lgkmcnt(11)
    v_mfma_f32_32x32x16_bf16 v[168:183], v[32:35], v[52:55], v[168:183]
    ds_read_b128 v[56:59], v9 offset:16384
    ds_read_b128 v[60:63], v9 offset:20480
    ds_read_u16 v225, v25 offset:952
    ds_read_u16 v226, v25 offset:1008
    s_waitcnt lgkmcnt(11)
    v_mfma_f32_32x32x16_bf16 v[184:199], v[48:51], v[36:39], v[184:199]
    ds_read_b64_tr_b16 v[44:45], v5 offset:12288
    ds_read_b64_tr_b16 v[46:47], v5 offset:13312
    s_add_u32 m0, s69, 90112
    s_add_u32 s74, s26, 172032
    buffer_load_dwordx4 v4, s[28:31], s74 offen lds
    ds_read_u16 v227, v25 offset:1064
    ds_read_u16 v228, v25 offset:1344
    v_mfma_f32_32x32x16_bf16 v[200:215], v[52:55], v[36:39], v[200:215]
    ds_read_u16 v229, v25 offset:1400
    ds_read_u16 v230, v25 offset:1456
    ds_read_u16 v231, v25 offset:1512
    s_waitcnt lgkmcnt(0)
    v_mfma_f32_32x32x16_bf16 v[152:167], v[40:43], v[56:59], v[152:167]
    s_waitcnt vmcnt(6)
    s_barrier
    v_mfma_f32_32x32x16_bf16 v[168:183], v[40:43], v[60:63], v[168:183]
    v_add_u32 v3, 0x18000, v3
    v_add_u32 v5, 0x18000, v5
    v_add_u32 v6, 0x18000, v6
    v_add_u32 v7, 0x18000, v7
    v_add_u32 v8, 0x18000, v8
    v_add_u32 v9, 0x18000, v9
    v_lshrrev_b32 v19, 3, v0
    v_lshlrev_b32 v19, 8, v19
    v_lshl_add_u32 v19, v0, 2, v19
    buffer_load_dword v16, v19, s[56:59], 0 offen sc1
    ds_read_b64_tr_b16 v[32:33], v3 offset:0
    ds_read_b64_tr_b16 v[34:35], v3 offset:1024
    ds_read_b128 v[48:51], v6 offset:16384
    v_mfma_f32_32x32x16_bf16 v[184:199], v[56:59], v[44:47], v[184:199]
    ds_read_b128 v[52:55], v6 offset:20480
    ds_read_b64_tr_b16 v[36:37], v5 offset:0
    ds_read_b64_tr_b16 v[38:39], v5 offset:1024
    v_lshl_or_b32 v144, v217, 16, v216
    v_mfma_f32_32x32x16_bf16 v[200:215], v[60:63], v[44:47], v[200:215]
    s_add_u32 s24, s24, 1
    s_cmp_eq_u32 s24, 7
    s_cselect_b32 s24, 0, s24
    s_mul_i32 s25, s24, 172032
    s_add_u32 s25, s25, s67
    s_lshl_b32 s26, s24, 7
    s_add_u32 s26, s26, s68
    v_and_b32 v144, v144, v26
    s_waitcnt lgkmcnt(3)
    v_mfma_f32_32x32x16_bf16 v[152:167], v[32:35], v[48:51], v[152:167]
    ds_read_b64_tr_b16 v[40:41], v3 offset:4096
    ds_read_b64_tr_b16 v[42:43], v3 offset:5120
    v_lshl_or_b32 v145, v219, 16, v218
    s_waitcnt lgkmcnt(4)
    v_mfma_f32_32x32x16_bf16 v[168:183], v[32:35], v[52:55], v[168:183]
    ds_read_b128 v[56:59], v7 offset:16384
    ds_read_b128 v[60:63], v7 offset:20480
    v_and_b32 v145, v145, v26
    s_waitcnt lgkmcnt(4)
    v_mfma_f32_32x32x16_bf16 v[184:199], v[48:51], v[36:39], v[184:199]
    ds_read_b64_tr_b16 v[44:45], v5 offset:4096
    ds_read_b64_tr_b16 v[46:47], v5 offset:5120
    s_add_u32 m0, s69, 0
    s_add_u32 s74, s25, 0
    buffer_load_dwordx4 v2, s[32:35], s74 offen lds
    v_lshl_or_b32 v146, v221, 16, v220
    v_mfma_f32_32x32x16_bf16 v[200:215], v[52:55], v[36:39], v[200:215]
    s_add_u32 m0, s69, 16384
    s_add_u32 s74, s26, 0
    buffer_load_dwordx4 v4, s[28:31], s74 offen lds
    v_and_b32 v146, v146, v26
    v_lshl_or_b32 v147, v223, 16, v222
    s_waitcnt lgkmcnt(3)
    v_mfma_f32_32x32x16_bf16 v[152:167], v[40:43], v[56:59], v[152:167]
    ds_read_b64_tr_b16 v[32:33], v3 offset:8192
    ds_read_b64_tr_b16 v[34:35], v3 offset:9216
    v_and_b32 v147, v147, v26
    s_waitcnt lgkmcnt(4)
    v_mfma_f32_32x32x16_bf16 v[168:183], v[40:43], v[60:63], v[168:183]
    ds_read_b128 v[48:51], v8 offset:16384
    ds_read_b128 v[52:55], v8 offset:20480
    s_add_u32 m0, s69, 32768
    s_add_u32 s74, s26, 114688
    buffer_load_dwordx4 v4, s[28:31], s74 offen lds
    v_lshl_or_b32 v148, v225, 16, v224
    s_waitcnt lgkmcnt(4)
    v_mfma_f32_32x32x16_bf16 v[184:199], v[56:59], v[44:47], v[184:199]
    ds_read_b64_tr_b16 v[36:37], v5 offset:8192
    ds_read_b64_tr_b16 v[38:39], v5 offset:9216
    v_and_b32 v148, v148, v26
    v_mfma_f32_32x32x16_bf16 v[200:215], v[60:63], v[44:47], v[200:215]
    s_add_u32 m0, s69, 8192
    s_add_u32 s74, s25, 86016
    buffer_load_dwordx4 v2, s[32:35], s74 offen lds
    v_lshl_or_b32 v149, v227, 16, v226
    s_waitcnt lgkmcnt(3)
    v_mfma_f32_32x32x16_bf16 v[152:167], v[32:35], v[48:51], v[152:167]
    ds_read_b64_tr_b16 v[40:41], v3 offset:12288
    ds_read_b64_tr_b16 v[42:43], v3 offset:13312
    s_add_u32 m0, s69, 24576
    s_add_u32 s74, s26, 57344
    buffer_load_dwordx4 v4, s[28:31], s74 offen lds
    v_and_b32 v149, v149, v26
    s_waitcnt lgkmcnt(4)
    v_mfma_f32_32x32x16_bf16 v[168:183], v[32:35], v[52:55], v[168:183]
    ds_read_b128 v[56:59], v9 offset:16384
    ds_read_b128 v[60:63], v9 offset:20480
    v_lshl_or_b32 v150, v229, 16, v228
    s_waitcnt lgkmcnt(4)
    v_mfma_f32_32x32x16_bf16 v[184:199], v[48:51], v[36:39], v[184:199]
    ds_read_b64_tr_b16 v[44:45], v5 offset:12288
    ds_read_b64_tr_b16 v[46:47], v5 offset:13312
    s_add_u32 m0, s69, 40960
    s_add_u32 s74, s26, 172032
    buffer_load_dwordx4 v4, s[28:31], s74 offen lds
    v_and_b32 v150, v150, v27
    v_mfma_f32_32x32x16_bf16 v[200:215], v[52:55], v[36:39], v[200:215]
    v_lshl_or_b32 v151, v231, 16, v230
    v_and_b32 v151, v151, v27
    s_waitcnt lgkmcnt(0)
    v_mfma_f32_32x32x16_bf16 v[152:167], v[40:43], v[56:59], v[152:167]
    s_waitcnt vmcnt(7)
    s_barrier
    v_mfma_f32_32x32x16_bf16 v[168:183], v[40:43], v[60:63], v[168:183]
    v_add_u32 v3, 0xffff4000, v3
    v_add_u32 v5, 0xffff4000, v5
    v_add_u32 v6, 0xffff4000, v6
    v_add_u32 v7, 0xffff4000, v7
    v_add_u32 v8, 0xffff4000, v8
    v_add_u32 v9, 0xffff4000, v9
    ds_read_b64_tr_b16 v[32:33], v3 offset:0
    ds_read_b64_tr_b16 v[34:35], v3 offset:1024
    ds_read_b128 v[132:135], v6 offset:16384
    v_mfma_f32_32x32x16_bf16 v[184:199], v[56:59], v[44:47], v[184:199]
    ds_read_b128 v[136:139], v6 offset:20480
    ds_read_b64_tr_b16 v[140:141], v5 offset:0
    ds_read_b64_tr_b16 v[142:143], v5 offset:1024
    v_mfma_f32_32x32x16_bf16 v[200:215], v[60:63], v[44:47], v[200:215]
    s_waitcnt lgkmcnt(3)
    v_mfma_f32_32x32x16_bf16 v[152:167], v[32:35], v[132:135], v[152:167]
    ds_read_b64_tr_b16 v[40:41], v3 offset:4096
    ds_read_b64_tr_b16 v[42:43], v3 offset:5120
    ds_read_b128 v[120:123], v7 offset:16384
    s_waitcnt lgkmcnt(5)
    v_mfma_f32_32x32x16_bf16 v[168:183], v[32:35], v[136:139], v[168:183]
    ds_read_b128 v[124:127], v7 offset:20480
    ds_read_b64_tr_b16 v[128:129], v5 offset:4096
    ds_read_b64_tr_b16 v[130:131], v5 offset:5120
    s_waitcnt lgkmcnt(3)
    v_mfma_f32_32x32x16_bf16 v[152:167], v[40:43], v[120:123], v[152:167]
    ds_read_b64_tr_b16 v[32:33], v3 offset:8192
    ds_read_b64_tr_b16 v[34:35], v3 offset:9216
    ds_read_b128 v[108:111], v8 offset:16384
    s_waitcnt lgkmcnt(5)
    v_mfma_f32_32x32x16_bf16 v[168:183], v[40:43], v[124:127], v[168:183]
    ds_read_b128 v[112:115], v8 offset:20480
    ds_read_b64_tr_b16 v[116:117], v5 offset:8192
    ds_read_b64_tr_b16 v[118:119], v5 offset:9216
    s_waitcnt lgkmcnt(3)
    v_mfma_f32_32x32x16_bf16 v[152:167], v[32:35], v[108:111], v[152:167]
    ds_read_b64_tr_b16 v[40:41], v3 offset:12288
    ds_read_b64_tr_b16 v[42:43], v3 offset:13312
    ds_read_b128 v[96:99], v9 offset:16384
    s_waitcnt lgkmcnt(5)
    v_mfma_f32_32x32x16_bf16 v[168:183], v[32:35], v[112:115], v[168:183]
    ds_read_b128 v[100:103], v9 offset:20480
    ds_read_b64_tr_b16 v[104:105], v5 offset:12288
    ds_read_b64_tr_b16 v[106:107], v5 offset:13312
    s_waitcnt lgkmcnt(0)
    v_mfma_f32_32x32x16_bf16 v[152:167], v[40:43], v[96:99], v[152:167]
    s_waitcnt vmcnt(0)
    s_barrier
    v_add_u32 v3, 0xffff4000, v3
    v_add_u32 v5, 0xffff4000, v5
    v_add_u32 v6, 0xffff4000, v6
    v_add_u32 v7, 0xffff4000, v7
    v_add_u32 v8, 0xffff4000, v8
    v_add_u32 v9, 0xffff4000, v9
    v_cmp_eq_u32 vcc, 0, v16
    s_nop 1
    s_and_b32 s74, vcc_lo, 63
    s_cbranch_scc0 L_ok14
    s_mov_b32 s75, 40000
L_sp14:
    s_sleep 2
    buffer_load_dword v16, v19, s[56:59], 0 offen sc1
    s_waitcnt vmcnt(0)
    v_cmp_eq_u32 vcc, 0, v16
    s_sub_u32 s75, s75, 1
    s_cmp_eq_u32 s75, 0
    s_cbranch_scc1 L_ok14
    s_and_b32 s74, vcc_lo, 63
    s_cbranch_scc1 L_sp14
L_ok14:
    ds_read_b64_tr_b16 v[32:33], v3 offset:0
    ds_read_b64_tr_b16 v[34:35], v3 offset:1024
    ds_read_b128 v[84:87], v6 offset:16384
    v_mfma_f32_32x32x16_bf16 v[168:183], v[40:43], v[100:103], v[168:183]
    ds_read_b128 v[88:91], v6 offset:20480
    ds_read_b64_tr_b16 v[92:93], v5 offset:0
    ds_read_b64_tr_b16 v[94:95], v5 offset:1024
    s_add_u32 m0, s4, 49152
    s_add_u32 s74, s5, 0
    buffer_load_dwordx4 v10, s[44:47], s74 offen lds
    s_waitcnt lgkmcnt(3)
    v_mfma_f32_32x32x16_bf16 v[152:167], v[32:35], v[84:87], v[152:167]
    ds_read_b64_tr_b16 v[40:41], v3 offset:4096
    ds_read_b64_tr_b16 v[42:43], v3 offset:5120
    ds_read_b128 v[72:75], v7 offset:16384
    s_add_u32 m0, s4, 50176
    s_add_u32 s74, s5, 7168
    buffer_load_dwordx4 v10, s[44:47], s74 offen lds
    s_waitcnt lgkmcnt(5)
    v_mfma_f32_32x32x16_bf16 v[168:183], v[32:35], v[88:91], v[168:183]
    ds_read_b128 v[76:79], v7 offset:20480
    ds_read_b64_tr_b16 v[80:81], v5 offset:4096
    ds_read_b64_tr_b16 v[82:83], v5 offset:5120
    s_add_u32 m0, s4, 51200
    s_add_u32 s74, s5, 14336
    buffer_load_dwordx4 v10, s[44:47], s74 offen lds
    s_waitcnt lgkmcnt(3)
    v_mfma_f32_32x32x16_bf16 v[152:167], v[40:43], v[72:75], v[152:167]
    ds_read_b64_tr_b16 v[32:33], v3 offset:8192
    ds_read_b64_tr_b16 v[34:35], v3 offset:9216
    ds_read_b128 v[60:63], v8 offset:16384
    s_add_u32 m0, s4, 52224
    s_add_u32 s74, s5, 21504
    buffer_load_dwordx4 v10, s[44:47], s74 offen lds
    s_waitcnt lgkmcnt(5)
    v_mfma_f32_32x32x16_bf16 v[168:183], v[40:43], v[76:79], v[168:183]
    ds_read_b128 v[64:67], v8 offset:20480
    ds_read_b64_tr_b16 v[68:69], v5 offset:8192
    ds_read_b64_tr_b16 v[70:71], v5 offset:9216
    s_add_u32 m0, s4, 53248
    s_add_u32 s74, s5, 28672
    buffer_load_dwordx4 v10, s[44:47], s74 offen lds
    s_waitcnt lgkmcnt(3)
    v_mfma_f32_32x32x16_bf16 v[152:167], v[32:35], v[60:63], v[152:167]
    ds_read_b64_tr_b16 v[40:41], v3 offset:12288
    ds_read_b64_tr_b16 v[42:43], v3 offset:13312
    ds_read_b128 v[48:51], v9 offset:16384
    s_add_u32 m0, s4, 54272
    s_add_u32 s74, s5, 35840
    buffer_load_dwordx4 v10, s[44:47], s74 offen lds
    s_waitcnt lgkmcnt(5)
    v_mfma_f32_32x32x16_bf16 v[168:183], v[32:35], v[64:67], v[168:183]
    ds_read_b128 v[52:55], v9 offset:20480
    ds_read_b64_tr_b16 v[56:57], v5 offset:12288
    ds_read_b64_tr_b16 v[58:59], v5 offset:13312
    s_waitcnt lgkmcnt(0)
    v_mfma_f32_32x32x16_bf16 v[152:167], v[40:43], v[48:51], v[152:167]
    s_barrier
    v_mfma_f32_32x32x16_bf16 v[168:183], v[40:43], v[52:55], v[168:183]
    s_nop 9
    v_cvt_pk_bf16_f32 v152, v152, v153
    v_cvt_pk_bf16_f32 v153, v154, v155
    v_cvt_pk_bf16_f32 v154, v156, v157
    v_cvt_pk_bf16_f32 v155, v158, v159
    v_cvt_pk_bf16_f32 v156, v160, v161
    v_cvt_pk_bf16_f32 v157, v162, v163
    v_cvt_pk_bf16_f32 v158, v164, v165
    v_cvt_pk_bf16_f32 v159, v166, v167
    v_mfma_f32_32x32x16_bf16 v[216:231], v[144:147], v[152:155], 0
    s_nop 0
    v_mfma_f32_32x32x16_bf16 v[216:231], v[148:151], v[156:159], v[216:231]
    v_cvt_pk_bf16_f32 v168, v168, v169
    v_cvt_pk_bf16_f32 v169, v170, v171
    v_cvt_pk_bf16_f32 v170, v172, v173
    v_cvt_pk_bf16_f32 v171, v174, v175
    v_cvt_pk_bf16_f32 v172, v176, v177
    v_cvt_pk_bf16_f32 v173, v178, v179
    v_cvt_pk_bf16_f32 v174, v180, v181
    v_cvt_pk_bf16_f32 v175, v182, v183
    v_mfma_f32_32x32x16_bf16 v[232:247], v[144:147], v[168:171], 0
    s_nop 0
    v_mfma_f32_32x32x16_bf16 v[232:247], v[148:151], v[172:175], v[232:247]
    s_add_u32 m0, s4, 0
    s_add_u32 s74, s5, 43008
    buffer_load_dwordx4 v10, s[44:47], s74 offen lds
    s_add_u32 m0, s4, 1024
    s_add_u32 s74, s5, 50176
    buffer_load_dwordx4 v10, s[44:47], s74 offen lds
    v_max3_f32 v32, v216, v217, v218
    v_max3_f32 v34, -v216, -v217, -v218
    v_max3_f32 v32, v32, v219, v220
    v_max3_f32 v34, v34, -v219, -v220
    v_max3_f32 v32, v32, v221, v222
    v_max3_f32 v34, v34, -v221, -v222
    v_max3_f32 v32, v32, v223, v224
    v_max3_f32 v34, v34, -v223, -v224
    v_max3_f32 v32, v32, v225, v226
    v_max3_f32 v34, v34, -v225, -v226
    v_max3_f32 v32, v32, v227, v228
    v_max3_f32 v34, v34, -v227, -v228
    v_max_f32 v32, v32, v229
    v_max_f32_e64 v34, v34, -v229
    v_max3_f32 v36, v232, v233, v234
    v_max3_f32 v38, -v232, -v233, -v234
    v_max3_f32 v36, v36, v235, v236
    v_max3_f32 v38, v38, -v235, -v236
    v_max3_f32 v36, v36, v237, v238
    v_max3_f32 v38, v38, -v237, -v238
    v_max3_f32 v36, v36, v239, v240
    v_max3_f32 v38, v38, -v239, -v240
    v_max3_f32 v36, v36, v241, v242
    v_max3_f32 v38, v38, -v241, -v242
    v_max3_f32 v36, v36, v243, v244
    v_max3_f32 v38, v38, -v243, -v244
    v_max_f32 v36, v36, v245
    v_max_f32_e64 v38, v38, -v245
    v_permlane32_swap_b32 v32, v34
    s_nop 0
    v_permlane32_swap_b32 v36, v38
    v_max_f32 v32, v32, v34
    v_max_f32 v36, v36, v38
    v_mul_f32_e64 v32, -s70, v32
    v_mul_f32_e64 v36, -s70, v36
    v_mov_b32 v34, v32
    v_mov_b32 v38, v36
    s_nop 0
    v_permlane32_swap_b32 v32, v34
    v_permlane32_swap_b32 v36, v38
    v_pk_fma_f32 v[152:153], v[216:217], s[70:71], v[32:33] op_sel_hi:[1,0,0]
    v_pk_fma_f32 v[216:217], v[216:217], s[70:71], v[34:35] op_sel_hi:[1,0,0] neg_lo:[1,0,0] neg_hi:[1,0,0]
    v_pk_fma_f32 v[154:155], v[218:219], s[70:71], v[32:33] op_sel_hi:[1,0,0]
    v_pk_fma_f32 v[218:219], v[218:219], s[70:71], v[34:35] op_sel_hi:[1,0,0] neg_lo:[1,0,0] neg_hi:[1,0,0]
    v_pk_fma_f32 v[156:157], v[220:221], s[70:71], v[32:33] op_sel_hi:[1,0,0]
    v_pk_fma_f32 v[220:221], v[220:221], s[70:71], v[34:35] op_sel_hi:[1,0,0] neg_lo:[1,0,0] neg_hi:[1,0,0]
    v_pk_fma_f32 v[158:159], v[222:223], s[70:71], v[32:33] op_sel_hi:[1,0,0]
    v_pk_fma_f32 v[222:223], v[222:223], s[70:71], v[34:35] op_sel_hi:[1,0,0] neg_lo:[1,0,0] neg_hi:[1,0,0]
    s_waitcnt vmcnt(6)
    ds_read_b64_tr_b16 v[20:21], v11 offset:49152
    ds_read_b64_tr_b16 v[22:23], v11 offset:50176
    ds_read_b64_tr_b16 v[24:25], v12 offset:49152
    ds_read_b64_tr_b16 v[26:27], v12 offset:50176
    v_pk_fma_f32 v[160:161], v[224:225], s[70:71], v[32:33] op_sel_hi:[1,0,0]
    v_pk_fma_f32 v[224:225], v[224:225], s[70:71], v[34:35] op_sel_hi:[1,0,0] neg_lo:[1,0,0] neg_hi:[1,0,0]
    v_pk_fma_f32 v[162:163], v[226:227], s[70:71], v[32:33] op_sel_hi:[1,0,0]
    v_pk_fma_f32 v[226:227], v[226:227], s[70:71], v[34:35] op_sel_hi:[1,0,0] neg_lo:[1,0,0] neg_hi:[1,0,0]
    v_pk_fma_f32 v[164:165], v[228:229], s[70:71], v[32:33] op_sel_hi:[1,0,0]
    v_pk_fma_f32 v[228:229], v[228:229], s[70:71], v[34:35] op_sel_hi:[1,0,0] neg_lo:[1,0,0] neg_hi:[1,0,0]
    v_pk_fma_f32 v[168:169], v[232:233], s[70:71], v[36:37] op_sel_hi:[1,0,0]
    v_pk_fma_f32 v[232:233], v[232:233], s[70:71], v[38:39] op_sel_hi:[1,0,0] neg_lo:[1,0,0] neg_hi:[1,0,0]
    v_pk_fma_f32 v[170:171], v[234:235], s[70:71], v[36:37] op_sel_hi:[1,0,0]
    v_pk_fma_f32 v[234:235], v[234:235], s[70:71], v[38:39] op_sel_hi:[1,0,0] neg_lo:[1,0,0] neg_hi:[1,0,0]
    v_pk_fma_f32 v[172:173], v[236:237], s[70:71], v[36:37] op_sel_hi:[1,0,0]
    v_pk_fma_f32 v[236:237], v[236:237], s[70:71], v[38:39] op_sel_hi:[1,0,0] neg_lo:[1,0,0] neg_hi:[1,0,0]
    v_pk_fma_f32 v[174:175], v[238:239], s[70:71], v[36:37] op_sel_hi:[1,0,0]
    v_pk_fma_f32 v[238:239], v[238:239], s[70:71], v[38:39] op_sel_hi:[1,0,0] neg_lo:[1,0,0] neg_hi:[1,0,0]
    v_pk_fma_f32 v[176:177], v[240:241], s[70:71], v[36:37] op_sel_hi:[1,0,0]
    v_pk_fma_f32 v[240:241], v[240:241], s[70:71], v[38:39] op_sel_hi:[1,0,0] neg_lo:[1,0,0] neg_hi:[1,0,0]
    v_pk_fma_f32 v[178:179], v[242:243], s[70:71], v[36:37] op_sel_hi:[1,0,0]
    v_pk_fma_f32 v[242:243], v[242:243], s[70:71], v[38:39] op_sel_hi:[1,0,0] neg_lo:[1,0,0] neg_hi:[1,0,0]
    v_pk_fma_f32 v[180:181], v[244:245], s[70:71], v[36:37] op_sel_hi:[1,0,0]
    v_pk_fma_f32 v[244:245], v[244:245], s[70:71], v[38:39] op_sel_hi:[1,0,0] neg_lo:[1,0,0] neg_hi:[1,0,0]
    v_mfma_f32_32x32x16_bf16 v[184:199], v[132:135], v[140:143], v[184:199]
    v_exp_f32 v152, v152
    v_exp_f32 v216, v216
    v_exp_f32 v153, v153
    v_exp_f32 v217, v217
    v_mfma_f32_32x32x16_bf16 v[200:215], v[136:139], v[140:143], v[200:215]
    v_exp_f32 v154, v154
    v_exp_f32 v218, v218
    s_waitcnt lgkmcnt(0)
    s_add_u32 m0, s4, 49152
    s_add_u32 s74, s5, 86016
    buffer_load_dwordx4 v10, s[44:47], s74 offen lds
    s_add_u32 m0, s4, 50176
    s_add_u32 s74, s5, 93184
    buffer_load_dwordx4 v10, s[44:47], s74 offen lds
    v_exp_f32 v155, v155
    v_mfma_f32_32x32x16_bf16 v[184:199], v[120:123], v[128:131], v[184:199]
    v_exp_f32 v219, v219
    v_exp_f32 v156, v156
    v_exp_f32 v220, v220
    v_exp_f32 v157, v157
    v_mfma_f32_32x32x16_bf16 v[200:215], v[124:127], v[128:131], v[200:215]
    v_exp_f32 v221, v221
    v_exp_f32 v158, v158
    v_exp_f32 v222, v222
    v_mfma_f32_32x32x16_bf16 v[184:199], v[108:111], v[116:119], v[184:199]
    v_exp_f32 v159, v159
    v_exp_f32 v223, v223
    v_exp_f32 v160, v160
    v_mfma_f32_32x32x16_bf16 v[200:215], v[112:115], v[116:119], v[200:215]
    v_exp_f32 v224, v224
    v_exp_f32 v161, v161
    v_exp_f32 v225, v225
    v_exp_f32 v162, v162
    v_mfma_f32_32x32x16_bf16 v[184:199], v[96:99], v[104:107], v[184:199]
    v_exp_f32 v226, v226
    v_exp_f32 v163, v163
    v_exp_f32 v227, v227
    v_mfma_f32_32x32x16_bf16 v[200:215], v[100:103], v[104:107], v[200:215]
    v_exp_f32 v164, v164
    v_exp_f32 v228, v228
    v_exp_f32 v165, v165
    v_exp_f32 v229, v229
    v_mfma_f32_32x32x16_bf16 v[184:199], v[84:87], v[92:95], v[184:199]
    v_exp_f32 v168, v168
    v_exp_f32 v232, v232
    v_exp_f32 v169, v169
    v_mfma_f32_32x32x16_bf16 v[200:215], v[88:91], v[92:95], v[200:215]
    v_exp_f32 v233, v233
    v_exp_f32 v170, v170
    v_exp_f32 v234, v234
    v_mfma_f32_32x32x16_bf16 v[184:199], v[72:75], v[80:83], v[184:199]
    v_exp_f32 v171, v171
    v_exp_f32 v235, v235
    v_exp_f32 v172, v172
    v_exp_f32 v236, v236
    v_mfma_f32_32x32x16_bf16 v[200:215], v[76:79], v[80:83], v[200:215]
    v_exp_f32 v173, v173
    v_exp_f32 v237, v237
    v_exp_f32 v174, v174
    v_mfma_f32_32x32x16_bf16 v[184:199], v[60:63], v[68:71], v[184:199]
    v_exp_f32 v238, v238
    v_exp_f32 v175, v175
    v_exp_f32 v239, v239
    v_exp_f32 v176, v176
    v_mfma_f32_32x32x16_bf16 v[200:215], v[64:67], v[68:71], v[200:215]
    v_exp_f32 v240, v240
    v_exp_f32 v177, v177
    v_exp_f32 v241, v241
    v_mfma_f32_32x32x16_bf16 v[184:199], v[48:51], v[56:59], v[184:199]
    v_exp_f32 v178, v178
    v_exp_f32 v242, v242
    v_exp_f32 v179, v179
    v_mfma_f32_32x32x16_bf16 v[200:215], v[52:55], v[56:59], v[200:215]
    v_exp_f32 v243, v243
    v_exp_f32 v180, v180
    v_exp_f32 v244, v244
    v_exp_f32 v181, v181
    v_exp_f32 v245, v245
    v_pk_add_f32 v[40:41], v[152:153], v[154:155]
    v_pk_add_f32 v[42:43], v[216:217], v[218:219]
    v_pk_add_f32 v[44:45], v[168:169], v[170:171]
    v_pk_add_f32 v[46:47], v[232:233], v[234:235]
    v_pk_add_f32 v[40:41], v[40:41], v[156:157]
    v_pk_add_f32 v[42:43], v[42:43], v[220:221]
    v_pk_add_f32 v[44:45], v[44:45], v[172:173]
    v_pk_add_f32 v[46:47], v[46:47], v[236:237]
    v_pk_add_f32 v[40:41], v[40:41], v[158:159]
    v_pk_add_f32 v[42:43], v[42:43], v[222:223]
    v_pk_add_f32 v[44:45], v[44:45], v[174:175]
    v_pk_add_f32 v[46:47], v[46:47], v[238:239]
    v_pk_add_f32 v[40:41], v[40:41], v[160:161]
    v_pk_add_f32 v[42:43], v[42:43], v[224:225]
    v_pk_add_f32 v[44:45], v[44:45], v[176:177]
    v_pk_add_f32 v[46:47], v[46:47], v[240:241]
    v_pk_add_f32 v[40:41], v[40:41], v[162:163]
    v_pk_add_f32 v[42:43], v[42:43], v[226:227]
    v_pk_add_f32 v[44:45], v[44:45], v[178:179]
    v_pk_add_f32 v[46:47], v[46:47], v[242:243]
    v_pk_add_f32 v[40:41], v[40:41], v[164:165]
    v_pk_add_f32 v[42:43], v[42:43], v[228:229]
    v_pk_add_f32 v[44:45], v[44:45], v[180:181]
    v_pk_add_f32 v[46:47], v[46:47], v[244:245]
    v_add_f32 v32, v40, v41
    v_add_f32 v34, v42, v43
    v_add_f32 v36, v44, v45
    v_add_f32 v38, v46, v47
    v_cvt_pk_bf16_f32 v184, v184, v185
    v_cvt_pk_bf16_f32 v185, v186, v187
    v_cvt_pk_bf16_f32 v186, v188, v189
    v_cvt_pk_bf16_f32 v187, v190, v191
    ds_write_b128 v254, v[184:187] offset:2048
    v_cvt_pk_bf16_f32 v188, v192, v193
    v_cvt_pk_bf16_f32 v189, v194, v195
    v_cvt_pk_bf16_f32 v190, v196, v197
    v_cvt_pk_bf16_f32 v191, v198, v199
    ds_write_b128 v254, v[188:191] offset:3072
    v_cvt_pk_bf16_f32 v200, v200, v201
    v_cvt_pk_bf16_f32 v201, v202, v203
    v_cvt_pk_bf16_f32 v202, v204, v205
    v_cvt_pk_bf16_f32 v203, v206, v207
    ds_write_b128 v254, v[200:203] offset:4096
    v_cvt_pk_bf16_f32 v204, v208, v209
    v_cvt_pk_bf16_f32 v205, v210, v211
    v_cvt_pk_bf16_f32 v206, v212, v213
    v_cvt_pk_bf16_f32 v207, v214, v215
    ds_write_b128 v254, v[204:207] offset:5120
    v_permlane32_swap_b32 v32, v34
    v_permlane32_swap_b32 v36, v38
    v_add_f32 v32, v32, v34
    v_add_f32 v36, v36, v38
    v_rcp_f32 v32, v32
    v_rcp_f32 v36, v36
    v_mov_b32 v34, v32
    v_mov_b32 v38, v36
    s_nop 0
    v_permlane32_swap_b32 v32, v34
    v_permlane32_swap_b32 v36, v38
    v_pk_mul_f32 v[152:153], v[152:153], v[32:33] op_sel_hi:[1,0]
    v_pk_mul_f32 v[154:155], v[154:155], v[32:33] op_sel_hi:[1,0]
    v_pk_mul_f32 v[156:157], v[156:157], v[32:33] op_sel_hi:[1,0]
    v_pk_mul_f32 v[158:159], v[158:159], v[32:33] op_sel_hi:[1,0]
    v_pk_mul_f32 v[160:161], v[160:161], v[32:33] op_sel_hi:[1,0]
    v_pk_mul_f32 v[162:163], v[162:163], v[32:33] op_sel_hi:[1,0]
    v_pk_mul_f32 v[164:165], v[164:165], v[32:33] op_sel_hi:[1,0]
    v_cvt_pk_bf16_f32 v152, v152, v153
    v_cvt_pk_bf16_f32 v153, v154, v155
    v_cvt_pk_bf16_f32 v154, v156, v157
    v_cvt_pk_bf16_f32 v155, v158, v159
    v_cvt_pk_bf16_f32 v156, v160, v161
    v_cvt_pk_bf16_f32 v157, v162, v163
    v_cvt_pk_bf16_f32 v158, v164, v165
    v_mov_b32 v159, 0
    ds_write_b128 v248, v[152:155] offset:0
    ds_write_b128 v249, v[156:159] offset:0
    v_pk_mul_f32 v[216:217], v[216:217], v[34:35] op_sel_hi:[1,0]
    v_pk_mul_f32 v[218:219], v[218:219], v[34:35] op_sel_hi:[1,0]
    v_pk_mul_f32 v[220:221], v[220:221], v[34:35] op_sel_hi:[1,0]
    v_pk_mul_f32 v[222:223], v[222:223], v[34:35] op_sel_hi:[1,0]
    v_pk_mul_f32 v[224:225], v[224:225], v[34:35] op_sel_hi:[1,0]
    v_pk_mul_f32 v[226:227], v[226:227], v[34:35] op_sel_hi:[1,0]
    v_pk_mul_f32 v[228:229], v[228:229], v[34:35] op_sel_hi:[1,0]
    v_cvt_pk_bf16_f32 v216, v216, v217
    v_cvt_pk_bf16_f32 v217, v218, v219
    v_cvt_pk_bf16_f32 v218, v220, v221
    v_cvt_pk_bf16_f32 v219, v222, v223
    v_cvt_pk_bf16_f32 v220, v224, v225
    v_cvt_pk_bf16_f32 v221, v226, v227
    v_cvt_pk_bf16_f32 v222, v228, v229
    v_mov_b32 v223, 0
    ds_write_b128 v248, v[216:219] offset:16384
    ds_write_b128 v249, v[220:223] offset:16384
    v_pk_mul_f32 v[168:169], v[168:169], v[36:37] op_sel_hi:[1,0]
    v_pk_mul_f32 v[170:171], v[170:171], v[36:37] op_sel_hi:[1,0]
    v_pk_mul_f32 v[172:173], v[172:173], v[36:37] op_sel_hi:[1,0]
    v_pk_mul_f32 v[174:175], v[174:175], v[36:37] op_sel_hi:[1,0]
    v_pk_mul_f32 v[176:177], v[176:177], v[36:37] op_sel_hi:[1,0]
    v_pk_mul_f32 v[178:179], v[178:179], v[36:37] op_sel_hi:[1,0]
    v_pk_mul_f32 v[180:181], v[180:181], v[36:37] op_sel_hi:[1,0]
    v_cvt_pk_bf16_f32 v168, v168, v169
    v_cvt_pk_bf16_f32 v169, v170, v171
    v_cvt_pk_bf16_f32 v170, v172, v173
    v_cvt_pk_bf16_f32 v171, v174, v175
    v_cvt_pk_bf16_f32 v172, v176, v177
    v_cvt_pk_bf16_f32 v173, v178, v179
    v_cvt_pk_bf16_f32 v174, v180, v181
    v_mov_b32 v175, 0
    ds_write_b128 v248, v[168:171] offset:2048
    ds_write_b128 v249, v[172:175] offset:2048
    v_pk_mul_f32 v[232:233], v[232:233], v[38:39] op_sel_hi:[1,0]
    v_pk_mul_f32 v[234:235], v[234:235], v[38:39] op_sel_hi:[1,0]
    v_pk_mul_f32 v[236:237], v[236:237], v[38:39] op_sel_hi:[1,0]
    v_pk_mul_f32 v[238:239], v[238:239], v[38:39] op_sel_hi:[1,0]
    v_pk_mul_f32 v[240:241], v[240:241], v[38:39] op_sel_hi:[1,0]
    v_pk_mul_f32 v[242:243], v[242:243], v[38:39] op_sel_hi:[1,0]
    v_pk_mul_f32 v[244:245], v[244:245], v[38:39] op_sel_hi:[1,0]
    v_cvt_pk_bf16_f32 v232, v232, v233
    v_cvt_pk_bf16_f32 v233, v234, v235
    v_cvt_pk_bf16_f32 v234, v236, v237
    v_cvt_pk_bf16_f32 v235, v238, v239
    v_cvt_pk_bf16_f32 v236, v240, v241
    v_cvt_pk_bf16_f32 v237, v242, v243
    v_cvt_pk_bf16_f32 v238, v244, v245
    v_mov_b32 v239, 0
    ds_write_b128 v248, v[232:235] offset:18432
    ds_write_b128 v249, v[236:239] offset:18432
    s_cmp_ge_u32 s60, 4
    s_cbranch_scc1 L_kv_skip
    s_waitcnt vmcnt(6)
    ds_read_b64_tr_b16 v[80:81], v11 offset:51200
    ds_read_b64_tr_b16 v[82:83], v11 offset:52224
    ds_read_b64_tr_b16 v[84:85], v12 offset:51200
    ds_read_b64_tr_b16 v[86:87], v12 offset:52224
    s_waitcnt vmcnt(4)
    ds_read_b64_tr_b16 v[88:89], v11 offset:53248
    ds_read_b64_tr_b16 v[90:91], v11 offset:54272
    ds_read_b64_tr_b16 v[92:93], v12 offset:53248
    ds_read_b64_tr_b16 v[94:95], v12 offset:54272
    s_waitcnt vmcnt(2)
    ds_read_b64_tr_b16 v[144:145], v11 offset:0
    ds_read_b64_tr_b16 v[146:147], v11 offset:1024
    ds_read_b64_tr_b16 v[148:149], v12 offset:0
    ds_read_b64_tr_b16 v[150:151], v12 offset:1024
    s_waitcnt lgkmcnt(8)
    s_add_u32 m0, s4, 51200
    s_add_u32 s74, s5, 100352
    buffer_load_dwordx4 v10, s[44:47], s74 offen lds
    s_add_u32 m0, s4, 52224
    s_add_u32 s74, s5, 107520
    buffer_load_dwordx4 v10, s[44:47], s74 offen lds
    s_waitcnt lgkmcnt(4)
    s_add_u32 m0, s4, 53248
    s_add_u32 s74, s5, 114688
    buffer_load_dwordx4 v10, s[44:47], s74 offen lds
    s_add_u32 m0, s4, 54272
    s_add_u32 s74, s5, 121856
    buffer_load_dwordx4 v10, s[44:47], s74 offen lds
    s_waitcnt lgkmcnt(0)
    s_add_u32 m0, s4, 0
    s_add_u32 s74, s5, 129024
    buffer_load_dwordx4 v10, s[44:47], s74 offen lds
    s_add_u32 m0, s4, 1024
    s_add_u32 s74, s5, 136192
    buffer_load_dwordx4 v10, s[44:47], s74 offen lds
L_kv_skip:
    s_waitcnt lgkmcnt(0)
    s_barrier
    s_cmp_ge_u32 s60, 4
    s_cbranch_scc1 L_kv_rest
    ds_read_b64_tr_b16 v[112:113], v252 offset:0
    ds_read_b64_tr_b16 v[114:115], v252 offset:512
    ds_read_b128 v[216:219], v255 offset:2048
    ds_read_b64_tr_b16 v[116:117], v252 offset:1024
    ds_read_b64_tr_b16 v[118:119], v252 offset:1536
    ds_read_b128 v[220:223], v255 offset:3072
    ds_read_b64_tr_b16 v[120:121], v252 offset:2048
    ds_read_b64_tr_b16 v[122:123], v252 offset:2560
    ds_read_b128 v[224:227], v255 offset:4096
    ds_read_b64_tr_b16 v[124:125], v252 offset:3072
    ds_read_b64_tr_b16 v[126:127], v252 offset:3584
    ds_read_b128 v[228:231], v255 offset:5120
    ds_read_b64_tr_b16 v[128:129], v252 offset:4096
    ds_read_b64_tr_b16 v[130:131], v252 offset:4608
    ds_read_b128 v[232:235], v255 offset:8192
    s_waitcnt lgkmcnt(12)
    v_mfma_f32_32x32x16_bf16 v[32:47], v[112:115], v[216:219], 0
    ds_read_b64_tr_b16 v[132:133], v252 offset:5120
    ds_read_b64_tr_b16 v[134:135], v252 offset:5632
    ds_read_b128 v[236:239], v255 offset:9216
    s_waitcnt lgkmcnt(12)
    v_mfma_f32_32x32x16_bf16 v[32:47], v[116:119], v[220:223], v[32:47]
    ds_read_b64_tr_b16 v[136:137], v252 offset:6144
    ds_read_b64_tr_b16 v[138:139], v252 offset:6656
    ds_read_b128 v[240:243], v255 offset:10240
    s_waitcnt lgkmcnt(12)
    v_mfma_f32_32x32x16_bf16 v[32:47], v[120:123], v[224:227], v[32:47]
    ds_read_b64_tr_b16 v[140:141], v252 offset:7168
    ds_read_b64_tr_b16 v[142:143], v252 offset:7680
    ds_read_b128 v[244:247], v255 offset:11264
    s_waitcnt lgkmcnt(12)
    v_mfma_f32_32x32x16_bf16 v[32:47], v[124:127], v[228:231], v[32:47]
    ds_read_b64_tr_b16 v[112:113], v252 offset:8192
    ds_read_b64_tr_b16 v[114:115], v252 offset:8704
    ds_read_b128 v[216:219], v255 offset:14336
    s_waitcnt lgkmcnt(12)
    v_mfma_f32_32x32x16_bf16 v[32:47], v[128:131], v[232:235], v[32:47]
    ds_read_b64_tr_b16 v[116:117], v252 offset:9216
    ds_read_b64_tr_b16 v[118:119], v252 offset:9728
    ds_read_b128 v[220:223], v255 offset:15360
    s_waitcnt lgkmcnt(12)
    v_mfma_f32_32x32x16_bf16 v[32:47], v[132:135], v[236:239], v[32:47]
    ds_read_b64_tr_b16 v[120:121], v252 offset:10240
    ds_read_b64_tr_b16 v[122:123], v252 offset:10752
    ds_read_b128 v[224:227], v255 offset:16384
    s_waitcnt lgkmcnt(12)
    v_mfma_f32_32x32x16_bf16 v[32:47], v[136:139], v[240:243], v[32:47]
    ds_read_b64_tr_b16 v[124:125], v252 offset:11264
    ds_read_b64_tr_b16 v[126:127], v252 offset:11776
    ds_read_b128 v[228:231], v255 offset:17408
    s_waitcnt lgkmcnt(12)
    v_mfma_f32_32x32x16_bf16 v[32:47], v[140:143], v[244:247], v[32:47]
    ds_read_b64_tr_b16 v[128:129], v252 offset:12288
    ds_read_b64_tr_b16 v[130:131], v252 offset:12800
    ds_read_b128 v[232:235], v255 offset:20480
    s_waitcnt lgkmcnt(12)
    v_mfma_f32_32x32x16_bf16 v[32:47], v[112:115], v[216:219], v[32:47]
    ds_read_b64_tr_b16 v[132:133], v252 offset:13312
    ds_read_b64_tr_b16 v[134:135], v252 offset:13824
    ds_read_b128 v[236:239], v255 offset:21504
    s_waitcnt lgkmcnt(12)
    v_mfma_f32_32x32x16_bf16 v[32:47], v[116:119], v[220:223], v[32:47]
    ds_read_b64_tr_b16 v[136:137], v252 offset:14336
    ds_read_b64_tr_b16 v[138:139], v252 offset:14848
    ds_read_b128 v[240:243], v255 offset:22528
    s_waitcnt lgkmcnt(12)
    v_mfma_f32_32x32x16_bf16 v[32:47], v[120:123], v[224:227], v[32:47]
    ds_read_b64_tr_b16 v[140:141], v252 offset:15360
    ds_read_b64_tr_b16 v[142:143], v252 offset:15872
    ds_read_b128 v[244:247], v255 offset:23552
    s_waitcnt lgkmcnt(12)
    v_mfma_f32_32x32x16_bf16 v[32:47], v[124:127], v[228:231], v[32:47]
    s_waitcnt lgkmcnt(9)
    v_mfma_f32_32x32x16_bf16 v[32:47], v[128:131], v[232:235], v[32:47]
    s_waitcnt lgkmcnt(6)
    v_mfma_f32_32x32x16_bf16 v[32:47], v[132:135], v[236:239], v[32:47]
    s_waitcnt lgkmcnt(3)
    v_mfma_f32_32x32x16_bf16 v[32:47], v[136:139], v[240:243], v[32:47]
    s_waitcnt lgkmcnt(0)
    v_mfma_f32_32x32x16_bf16 v[32:47], v[140:143], v[244:247], v[32:47]
    s_nop 11
    v_cvt_pk_bf16_f32 v32, v32, v33
    v_cvt_pk_bf16_f32 v33, v34, v35
    v_cvt_pk_bf16_f32 v34, v36, v37
    v_cvt_pk_bf16_f32 v35, v38, v39
    buffer_store_dwordx4 v[32:35], v1, s[40:43], s76 offen sc1
    v_cvt_pk_bf16_f32 v36, v40, v41
    v_cvt_pk_bf16_f32 v37, v42, v43
    v_cvt_pk_bf16_f32 v38, v44, v45
    buffer_store_dwordx3 v[36:38], v250, s[40:43], s77 offen sc1
    s_barrier
    s_waitcnt vmcnt(2)
    s_add_u32 m0, s4, 2048
    s_add_u32 s74, s5, 57344
    buffer_load_dwordx4 v10, s[44:47], s74 offen lds
    s_add_u32 m0, s4, 3072
    s_add_u32 s74, s5, 64512
    buffer_load_dwordx4 v10, s[44:47], s74 offen lds
    s_add_u32 m0, s4, 4096
    s_add_u32 s74, s5, 71680
    buffer_load_dwordx4 v10, s[44:47], s74 offen lds
    s_add_u32 m0, s4, 5120
    s_add_u32 s74, s5, 78848
    buffer_load_dwordx4 v10, s[44:47], s74 offen lds
    s_waitcnt vmcnt(4)
    buffer_load_dword v28, v251, s[40:43], s76 offen sc1
    s_setprio 0
    s_branch L_stage3
L_kv_rest:
    s_waitcnt vmcnt(0)
    ds_read_b64_tr_b16 v[80:81], v11 offset:51200
    ds_read_b64_tr_b16 v[82:83], v11 offset:52224
    ds_read_b64_tr_b16 v[84:85], v12 offset:51200
    ds_read_b64_tr_b16 v[86:87], v12 offset:52224
    ds_read_b64_tr_b16 v[88:89], v11 offset:53248
    ds_read_b64_tr_b16 v[90:91], v11 offset:54272
    ds_read_b64_tr_b16 v[92:93], v12 offset:53248
    ds_read_b64_tr_b16 v[94:95], v12 offset:54272
    ds_read_b64_tr_b16 v[144:145], v11 offset:0
    ds_read_b64_tr_b16 v[146:147], v11 offset:1024
    ds_read_b64_tr_b16 v[148:149], v12 offset:0
    ds_read_b64_tr_b16 v[150:151], v12 offset:1024
    s_waitcnt lgkmcnt(8)
    s_add_u32 m0, s4, 51200
    s_add_u32 s74, s5, 100352
    buffer_load_dwordx4 v10, s[44:47], s74 offen lds
    s_add_u32 m0, s4, 52224
    s_add_u32 s74, s5, 107520
    buffer_load_dwordx4 v10, s[44:47], s74 offen lds
    s_waitcnt lgkmcnt(4)
    s_add_u32 m0, s4, 53248
    s_add_u32 s74, s5, 114688
    buffer_load_dwordx4 v10, s[44:47], s74 offen lds
    s_add_u32 m0, s4, 54272
    s_add_u32 s74, s5, 121856
    buffer_load_dwordx4 v10, s[44:47], s74 offen lds
    s_waitcnt lgkmcnt(0)
    s_add_u32 m0, s4, 0
    s_add_u32 s74, s5, 129024
    buffer_load_dwordx4 v10, s[44:47], s74 offen lds
    s_add_u32 m0, s4, 1024
    s_add_u32 s74, s5, 136192
    buffer_load_dwordx4 v10, s[44:47], s74 offen lds
    s_barrier
    s_waitcnt vmcnt(0)
L_stage:
    s_setprio 0
    s_add_u32 m0, s4, 2048
    s_add_u32 s74, s5, 57344
    buffer_load_dwordx4 v10, s[44:47], s74 offen lds
    s_add_u32 m0, s4, 3072
    s_add_u32 s74, s5, 64512
    buffer_load_dwordx4 v10, s[44:47], s74 offen lds
    s_add_u32 m0, s4, 4096
    s_add_u32 s74, s5, 71680
    buffer_load_dwordx4 v10, s[44:47], s74 offen lds
    s_add_u32 m0, s4, 5120
    s_add_u32 s74, s5, 78848
    buffer_load_dwordx4 v10, s[44:47], s74 offen lds
L_stage3:
    ds_read_b64_tr_b16 v[168:169], v11 offset:49152
    ds_read_b64_tr_b16 v[170:171], v11 offset:50176
    ds_read_b64_tr_b16 v[172:173], v12 offset:49152
    ds_read_b64_tr_b16 v[174:175], v12 offset:50176
    ds_read_b64_tr_b16 v[176:177], v11 offset:51200
    ds_read_b64_tr_b16 v[178:179], v11 offset:52224
    ds_read_b64_tr_b16 v[180:181], v12 offset:51200
    ds_read_b64_tr_b16 v[182:183], v12 offset:52224
    ds_read_b64_tr_b16 v[184:185], v11 offset:53248
    ds_read_b64_tr_b16 v[186:187], v11 offset:54272
    ds_read_b64_tr_b16 v[188:189], v12 offset:53248
    ds_read_b64_tr_b16 v[190:191], v12 offset:54272
    ds_read_b64_tr_b16 v[192:193], v11 offset:0
    ds_read_b64_tr_b16 v[194:195], v11 offset:1024
    ds_read_b64_tr_b16 v[196:197], v12 offset:0
    ds_read_b64_tr_b16 v[198:199], v12 offset:1024
    s_waitcnt lgkmcnt(4)
    s_add_u32 m0, s4, 53248
    s_add_u32 s74, s5, 172032
    buffer_load_dwordx4 v10, s[44:47], s74 offen lds
    s_add_u32 m0, s4, 54272
    s_add_u32 s74, s5, 179200
    buffer_load_dwordx4 v10, s[44:47], s74 offen lds
    s_waitcnt lgkmcnt(0)
    s_add_u32 m0, s4, 0
    s_add_u32 s74, s5, 186368
    buffer_load_dwordx4 v10, s[44:47], s74 offen lds
    s_add_u32 m0, s4, 1024
    s_add_u32 s74, s5, 193536
    buffer_load_dwordx4 v10, s[44:47], s74 offen lds
    s_add_u32 m0, s4, 49152
    s_add_u32 s74, s10, 25088
    buffer_load_dwordx4 v10, s[48:51], s74 offen lds
    s_add_u32 m0, s4, 50176
    s_add_u32 s74, s10, 32256
    buffer_load_dwordx4 v10, s[48:51], s74 offen lds
    s_add_u32 m0, s4, 51200
    s_add_u32 s74, s10, 39424
    buffer_load_dwordx4 v10, s[48:51], s74 offen lds
    s_add_u32 m0, s4, 52224
    s_add_u32 s74, s10, 46592
    buffer_load_dwordx4 v15, s[48:51], s74 offen lds
    s_waitcnt vmcnt(10)
    ds_read_b64_tr_b16 v[152:153], v11 offset:2048
    ds_read_b64_tr_b16 v[154:155], v11 offset:3072
    ds_read_b64_tr_b16 v[156:157], v12 offset:2048
    ds_read_b64_tr_b16 v[158:159], v12 offset:3072
    s_waitcnt vmcnt(8)
    ds_read_b64_tr_b16 v[160:161], v11 offset:4096
    ds_read_b64_tr_b16 v[162:163], v11 offset:5120
    ds_read_b64_tr_b16 v[164:165], v12 offset:4096
    ds_read_b64_tr_b16 v[166:167], v12 offset:5120
    s_waitcnt lgkmcnt(4)
    s_add_u32 m0, s4, 2048
    s_add_u32 s74, s5, 143360
    buffer_load_dwordx4 v10, s[44:47], s74 offen lds
    s_add_u32 m0, s4, 3072
    s_add_u32 s74, s5, 150528
    buffer_load_dwordx4 v10, s[44:47], s74 offen lds
    s_waitcnt lgkmcnt(0)
    s_add_u32 m0, s4, 4096
    s_add_u32 s74, s5, 157696
    buffer_load_dwordx4 v10, s[44:47], s74 offen lds
    s_add_u32 m0, s4, 5120
    s_add_u32 s74, s5, 164864
    buffer_load_dwordx4 v10, s[44:47], s74 offen lds
    buffer_load_dword v16, v13, s[40:43], s11 offen sc1
    s_add_u32 m0, s27, 98304
    s_add_u32 s74, s10, 0
    buffer_load_dwordx4 v10, s[48:51], s74 offen lds
    s_add_u32 m0, s27, 99328
    s_add_u32 s74, s10, 7168
    buffer_load_dwordx4 v10, s[48:51], s74 offen lds
    s_add_u32 m0, s27, 100352
    s_add_u32 s74, s10, 14336
    buffer_load_dwordx4 v10, s[48:51], s74 offen lds
    s_add_u32 m0, s27, 101376
    s_add_u32 s74, s10, 21504
    buffer_load_dwordx4 v15, s[48:51], s74 offen lds
    s_waitcnt vmcnt(7)
    ds_read_b64_tr_b16 v[96:97], v11 offset:2048
    ds_read_b64_tr_b16 v[98:99], v11 offset:3072
    ds_read_b64_tr_b16 v[100:101], v12 offset:2048
    ds_read_b64_tr_b16 v[102:103], v12 offset:3072
    s_waitcnt vmcnt(5)
    ds_read_b64_tr_b16 v[104:105], v11 offset:4096
    ds_read_b64_tr_b16 v[106:107], v11 offset:5120
    ds_read_b64_tr_b16 v[108:109], v12 offset:4096
    ds_read_b64_tr_b16 v[110:111], v12 offset:5120
    s_waitcnt vmcnt(4) lgkmcnt(0)
L_join:
    v_cmp_eq_u32 vcc, 0, v16
    s_nop 1
    s_and_b32 s74, vcc_lo, 7
    s_cbranch_scc0 L_ok10
    s_mov_b32 s75, 40000
L_sp10:
    s_sleep 2
    buffer_load_dword v16, v13, s[40:43], s11 offen sc1
    s_waitcnt vmcnt(0)
    v_cmp_eq_u32 vcc, 0, v16
    s_sub_u32 s75, s75, 1
    s_cmp_eq_u32 s75, 0
    s_cbranch_scc1 L_ok10
    s_and_b32 s74, vcc_lo, 7
    s_cbranch_scc1 L_sp10
L_ok10:
    buffer_load_dwordx4 v[200:203], v1, s[40:43], s83 offen offset:0 sc1
    buffer_load_dwordx4 v[204:207], v1, s[40:43], s83 offen offset:1024 sc1
    buffer_load_dwordx4 v[208:211], v1, s[40:43], s83 offen offset:2048 sc1
    buffer_load_dwordx4 v[212:215], v1, s[40:43], s83 offen offset:3072 sc1
    s_add_u32 s83, s83, 4096
    buffer_load_dwordx4 v[216:219], v1, s[40:43], s83 offen offset:0 sc1
    buffer_load_dwordx4 v[220:223], v1, s[40:43], s83 offen offset:1024 sc1
L_join2:
    s_setprio 0
    ds_read_b64_tr_b16 v[112:113], v11 offset:53248
    ds_read_b64_tr_b16 v[114:115], v11 offset:54272
    ds_read_b64_tr_b16 v[116:117], v12 offset:53248
    ds_read_b64_tr_b16 v[118:119], v12 offset:54272
    ds_read_b64_tr_b16 v[120:121], v11 offset:0
    ds_read_b64_tr_b16 v[122:123], v11 offset:1024
    ds_read_b64_tr_b16 v[124:125], v12 offset:0
    ds_read_b64_tr_b16 v[126:127], v12 offset:1024
    s_waitcnt vmcnt(5)
    v_mfma_f32_32x32x16_bf16 v[32:47], v[20:23], v[200:203], 0
    s_sub_u32 s63, s81, s80
    s_sub_u32 s63, s63, 1
    s_lshl_b32 s63, s63, 7
    v_lshrrev_b32 v29, 5, v0
    v_mfma_f32_32x32x16_bf16 v[48:63], v[24:27], v[200:203], 0
    buffer_load_dwordx4 v[224:227], v1, s[40:43], s83 offen offset:2048 sc1
    v_mul_u32_u24 v28, s63, v29
    v_lshl_add_u32 v254, v0, 2, v28
    s_lshl_b32 s87, s80, 7
    s_add_u32 s87, s87, 0x9c4000
    s_waitcnt vmcnt(5)
    v_mfma_f32_32x32x16_bf16 v[32:47], v[80:83], v[204:207], v[32:47]
    v_bfe_u32 v28, v0, 2, 1
    v_and_b32 v8, 0x38, v11
    v_lshl_add_u32 v8, v28, 7, v8
    v_mfma_f32_32x32x16_bf16 v[48:63], v[84:87], v[204:207], v[48:63]
    buffer_load_dwordx4 v[228:231], v1, s[40:43], s83 offen offset:3072 sc1
    v_mul_u32_u24 v28, 320, v29
    v_add3_u32 v8, v8, v28, s4
    v_xor_b32 v9, 64, v8
    v_lshlrev_b32 v28, 6, v29
    s_waitcnt vmcnt(5)
    v_mfma_f32_32x32x16_bf16 v[32:47], v[88:91], v[208:211], v[32:47]
    v_xor_b32 v28, v28, v1
    v_add_u32 v3, s4, v28
    v_xor_b32 v7, 0x80, v3
    s_and_b32 s63, s60, 3
    v_mfma_f32_32x32x16_bf16 v[48:63], v[92:95], v[208:211], v[48:63]
    s_add_u32 s83, s83, 4096
    buffer_load_dwordx4 v[232:235], v1, s[40:43], s83 offen offset:0 sc1
    s_lshl_b32 s63, s63, 3
    s_cmp_lt_u32 s60, 4
    s_cselect_b32 s64, 49152, 0
    s_waitcnt vmcnt(5)
    v_mfma_f32_32x32x16_bf16 v[32:47], v[144:147], v[212:215], v[32:47]
    v_bfe_u32 v28, v0, 3, 1
    v_bfe_u32 v30, v0, 4, 1
    v_cmp_eq_u32 s[76:77], v28, v30
    v_lshl_add_u32 v28, v29, 1, v28
    v_mfma_f32_32x32x16_bf16 v[48:63], v[148:151], v[212:215], v[48:63]
    buffer_load_dwordx4 v[236:239], v1, s[40:43], s83 offen offset:1024 sc1
    v_lshl_add_u32 v28, v30, 2, v28
    v_mul_u32_u24 v6, 896, v28
    v_and_b32 v2, 7, v0
    v_lshl_add_u32 v6, v2, 4, v6
    s_waitcnt vmcnt(5)
    v_mfma_f32_32x32x16_bf16 v[32:47], v[152:155], v[216:219], v[32:47]
    v_mul_u32_u24 v4, 6144, v29
    v_lshl_add_u32 v4, v2, 9, v4
    v_bfe_u32 v28, v0, 3, 2
    v_mfma_f32_32x32x16_bf16 v[48:63], v[156:159], v[216:219], v[48:63]
    buffer_load_dwordx4 v[240:243], v1, s[40:43], s83 offen offset:2048 sc1
    v_add_u32 v28, s63, v28
    v_and_b32 v29, 3, v0
    v_lshlrev_b32 v29, 2, v29
    v_xor_b32 v28, v28, v29
    s_waitcnt vmcnt(5)
    v_mfma_f32_32x32x16_bf16 v[32:47], v[160:163], v[220:223], v[32:47]
    v_lshlrev_b32 v28, 4, v28
    v_add3_u32 v4, v4, v28, s64
    v_xor_b32 v255, 64, v4
    v_mul_u32_u24 v5, 12, v0
    v_mfma_f32_32x32x16_bf16 v[48:63], v[164:167], v[220:223], v[48:63]
    buffer_load_dword v16, v13, s[40:43], s12 offen sc1
    buffer_load_dwordx4 v[244:247], v1, s[40:43], s83 offen offset:3072 sc1
    v_and_b32 v30, 1, v2
    v_lshlrev_b32 v30, 4, v30
    v_mov_b32 v31, 0x3f80
    s_waitcnt vmcnt(6)
    v_mfma_f32_32x32x16_bf16 v[32:47], v[168:171], v[224:227], v[32:47]
    v_lshlrev_b32 v30, v30, v31
    v_cndmask_b32_e64 v30, 0, v30, s[76:77]
    v_lshrrev_b32 v31, 1, v2
    v_cmp_eq_u32 vcc, 0, v31
    v_mfma_f32_32x32x16_bf16 v[48:63], v[172:175], v[224:227], v[48:63]
    s_add_u32 s83, s83, 4096
    buffer_load_dwordx4 v[200:203], v1, s[40:43], s83 offen offset:0 sc1
    v_cndmask_b32_e64 v248, 0, v30, vcc
    v_cmp_eq_u32 vcc, 1, v31
    s_nop 1
    v_cndmask_b32_e64 v249, 0, v30, vcc
    v_cmp_eq_u32 vcc, 2, v31
    s_waitcnt vmcnt(6)
    v_mfma_f32_32x32x16_bf16 v[32:47], v[176:179], v[228:231], v[32:47]
    v_cndmask_b32_e64 v250, 0, v30, vcc
    v_cmp_eq_u32 vcc, 3, v31
    s_nop 1
    v_cndmask_b32_e64 v251, 0, v30, vcc
    v_mfma_f32_32x32x16_bf16 v[48:63], v[180:183], v[228:231], v[48:63]
    buffer_load_dwordx4 v[204:207], v1, s[40:43], s83 offen offset:1024 sc1
    s_waitcnt vmcnt(6)
    v_mfma_f32_32x32x16_bf16 v[32:47], v[184:187], v[232:235], v[32:47]
    v_mfma_f32_32x32x16_bf16 v[48:63], v[188:191], v[232:235], v[48:63]
    s_waitcnt vmcnt(3)
    v_cmp_eq_u32 vcc, 0, v16
    s_nop 1
    s_and_b32 s74, vcc_lo, 7
    s_cbranch_scc0 L_ok11
    s_mov_b32 s75, 40000
L_sp11:
    s_sleep 2
    buffer_load_dword v16, v13, s[40:43], s12 offen sc1
    s_waitcnt vmcnt(0)
    v_cmp_eq_u32 vcc, 0, v16
    s_sub_u32 s75, s75, 1
    s_cmp_eq_u32 s75, 0
    s_cbranch_scc1 L_ok11
    s_and_b32 s74, vcc_lo, 7
    s_cbranch_scc1 L_sp11
L_ok11:
    buffer_load_dwordx4 v[208:211], v1, s[40:43], s84 offen offset:0 sc1
    v_mfma_f32_32x32x16_bf16 v[32:47], v[192:195], v[236:239], v[32:47]
    v_mfma_f32_32x32x16_bf16 v[48:63], v[196:199], v[236:239], v[48:63]
    buffer_load_dword v16, v254, s[40:43], s87 offen sc1
    buffer_load_dwordx4 v[212:215], v1, s[40:43], s84 offen offset:1024 sc1
    v_mfma_f32_32x32x16_bf16 v[32:47], v[96:99], v[240:243], v[32:47]
    v_mfma_f32_32x32x16_bf16 v[48:63], v[100:103], v[240:243], v[48:63]
    buffer_load_dwordx4 v[216:219], v1, s[40:43], s84 offen offset:2048 sc1
    s_waitcnt vmcnt(6)
    v_mfma_f32_32x32x16_bf16 v[32:47], v[104:107], v[244:247], v[32:47]
    v_mfma_f32_32x32x16_bf16 v[48:63], v[108:111], v[244:247], v[48:63]
    buffer_load_dwordx4 v[220:223], v1, s[40:43], s84 offen offset:3072 sc1
    s_waitcnt vmcnt(6) lgkmcnt(6)
    v_mfma_f32_32x32x16_bf16 v[32:47], v[112:115], v[200:203], v[32:47]
    s_waitcnt lgkmcnt(4)
    v_mfma_f32_32x32x16_bf16 v[48:63], v[116:119], v[200:203], v[48:63]
    s_add_u32 s84, s84, 4096
    buffer_load_dwordx4 v[224:227], v1, s[40:43], s84 offen offset:0 sc1
    s_waitcnt vmcnt(6) lgkmcnt(2)
    v_mfma_f32_32x32x16_bf16 v[32:47], v[120:123], v[204:207], v[32:47]
    s_waitcnt lgkmcnt(0)
    v_mfma_f32_32x32x16_bf16 v[48:63], v[124:127], v[204:207], v[48:63]
    buffer_load_dwordx4 v[228:231], v1, s[40:43], s84 offen offset:1024 sc1
    s_waitcnt vmcnt(6)
    v_mfma_f32_32x32x16_bf16 v[64:79], v[20:23], v[208:211], 0
    v_mfma_f32_32x32x16_bf16 v[128:143], v[24:27], v[208:211], 0
    buffer_load_dwordx4 v[232:235], v1, s[40:43], s84 offen offset:2048 sc1
    s_waitcnt vmcnt(5)
    v_mfma_f32_32x32x16_bf16 v[64:79], v[80:83], v[212:215], v[64:79]
    v_mfma_f32_32x32x16_bf16 v[128:143], v[84:87], v[212:215], v[128:143]
    v_cmp_eq_u32 vcc, 0, v16
    s_nop 1
    s_cmp_lg_u64 vcc, 0
    s_cbranch_scc0 L_ok12
    s_mov_b32 s75, 40000
L_sp12:
    s_sleep 2
    buffer_load_dword v16, v254, s[40:43], s87 offen sc1
    s_waitcnt vmcnt(0)
    v_cmp_eq_u32 vcc, 0, v16
    s_sub_u32 s75, s75, 1
    s_cmp_eq_u32 s75, 0
    s_cbranch_scc1 L_ok12
    s_cmp_lg_u64 vcc, 0
    s_cbranch_scc1 L_sp12
L_ok12:
    v_and_b32 v252, 0x7fffffff, v16
    v_and_b32 v253, 0x7fffffff, v16
    s_nop 1
    v_permlane32_swap_b32 v252, v253
    buffer_load_dwordx4 v[236:239], v1, s[40:43], s84 offen offset:3072 sc1
    s_waitcnt vmcnt(5)
    v_mfma_f32_32x32x16_bf16 v[64:79], v[88:91], v[216:219], v[64:79]
    v_mul_f32 v32, v32, v252
    v_mul_f32 v33, v33, v252
    v_mul_f32 v34, v34, v252
    v_mul_f32 v35, v35, v252
    v_mfma_f32_32x32x16_bf16 v[128:143], v[92:95], v[216:219], v[128:143]
    v_mul_f32 v36, v36, v252
    v_mul_f32 v37, v37, v252
    v_mul_f32 v38, v38, v252
    v_mul_f32 v39, v39, v252
    s_add_u32 s84, s84, 4096
    buffer_load_dwordx4 v[240:243], v1, s[40:43], s84 offen offset:0 sc1
    s_waitcnt vmcnt(5)
    v_mfma_f32_32x32x16_bf16 v[64:79], v[144:147], v[220:223], v[64:79]
    v_mul_f32 v40, v40, v252
    v_mul_f32 v41, v41, v252
    v_mul_f32 v42, v42, v252
    v_mul_f32 v43, v43, v252
    v_mfma_f32_32x32x16_bf16 v[128:143], v[148:151], v[220:223], v[128:143]
    v_mul_f32 v44, v44, v252
    v_mul_f32 v45, v45, v252
    v_mul_f32 v46, v46, v252
    v_mul_f32 v47, v47, v252
    buffer_load_dwordx4 v[244:247], v1, s[40:43], s84 offen offset:1024 sc1
    s_waitcnt vmcnt(5)
    v_mfma_f32_32x32x16_bf16 v[64:79], v[152:155], v[224:227], v[64:79]
    v_mul_f32 v48, v48, v252
    v_mul_f32 v49, v49, v252
    v_mul_f32 v50, v50, v252
    v_mul_f32 v51, v51, v252
    v_mfma_f32_32x32x16_bf16 v[128:143], v[156:159], v[224:227], v[128:143]
    v_mul_f32 v52, v52, v252
    v_mul_f32 v53, v53, v252
    v_mul_f32 v54, v54, v252
    v_mul_f32 v55, v55, v252
    buffer_load_dwordx4 v[200:203], v1, s[40:43], s84 offen offset:2048 sc1
    s_waitcnt vmcnt(5)
    v_mfma_f32_32x32x16_bf16 v[64:79], v[160:163], v[228:231], v[64:79]
    v_mul_f32 v56, v56, v252
    v_mul_f32 v57, v57, v252
    v_mul_f32 v58, v58, v252
    v_mul_f32 v59, v59, v252
    v_mfma_f32_32x32x16_bf16 v[128:143], v[164:167], v[228:231], v[128:143]
    v_mul_f32 v60, v60, v252
    v_mul_f32 v61, v61, v252
    v_mul_f32 v62, v62, v252
    v_mul_f32 v63, v63, v252
    buffer_load_dword v16, v14, s[40:43], s13 offen sc1
    buffer_load_dwordx4 v[204:207], v1, s[40:43], s84 offen offset:3072 sc1
    s_waitcnt vmcnt(6)
    v_mfma_f32_32x32x16_bf16 v[64:79], v[168:171], v[232:235], v[64:79]
    v_mfma_f32_32x32x16_bf16 v[128:143], v[172:175], v[232:235], v[128:143]
    ds_read_b64_tr_b16 v[144:145], v11 offset:49152
    ds_read_b64_tr_b16 v[146:147], v11 offset:50176
    ds_read_b64_tr_b16 v[148:149], v12 offset:49152
    ds_read_b64_tr_b16 v[150:151], v12 offset:50176
    ds_read_b64_tr_b16 v[152:153], v11 offset:51200
    ds_read_b64_tr_b16 v[154:155], v8 offset:52224
    ds_read_b64_tr_b16 v[156:157], v12 offset:51200
    ds_read_b64_tr_b16 v[158:159], v9 offset:52224
    s_lshl_b32 s63, s60, 11
    s_add_u32 s63, s63, 98304
    v_add_u32 v11, s63, v11
    v_add_u32 v12, s63, v12
    v_add_u32 v8, s63, v8
    v_add_u32 v9, s63, v9
    ds_read_b64_tr_b16 v[80:81], v11 offset:0
    ds_read_b64_tr_b16 v[82:83], v11 offset:1024
    ds_read_b64_tr_b16 v[84:85], v12 offset:0
    ds_read_b64_tr_b16 v[86:87], v12 offset:1024
    ds_read_b64_tr_b16 v[88:89], v11 offset:2048
    ds_read_b64_tr_b16 v[90:91], v8 offset:3072
    ds_read_b64_tr_b16 v[92:93], v12 offset:2048
    ds_read_b64_tr_b16 v[94:95], v9 offset:3072
    s_add_u32 s84, s84, 4096
    buffer_load_dwordx4 v[208:211], v1, s[40:43], s84 offen offset:0 sc1
    s_waitcnt vmcnt(6)
    v_mfma_f32_32x32x16_bf16 v[64:79], v[176:179], v[236:239], v[64:79]
    v_mfma_f32_32x32x16_bf16 v[128:143], v[180:183], v[236:239], v[128:143]
    buffer_load_dwordx4 v[212:215], v1, s[40:43], s84 offen offset:1024 sc1
    s_waitcnt vmcnt(6)
    v_mfma_f32_32x32x16_bf16 v[64:79], v[184:187], v[240:243], v[64:79]
    v_mfma_f32_32x32x16_bf16 v[128:143], v[188:191], v[240:243], v[128:143]
    s_waitcnt vmcnt(5)
    v_mfma_f32_32x32x16_bf16 v[64:79], v[192:195], v[244:247], v[64:79]
    v_mfma_f32_32x32x16_bf16 v[128:143], v[196:199], v[244:247], v[128:143]
    s_waitcnt vmcnt(3)
    v_cmp_eq_u32 vcc, 0, v16
    s_nop 1
    s_and_b32 s74, vcc_lo, 3
    s_cbranch_scc0 L_o_late
    v_mfma_f32_32x32x16_bf16 v[64:79], v[96:99], v[200:203], v[64:79]
    v_mfma_f32_32x32x16_bf16 v[128:143], v[100:103], v[200:203], v[128:143]
    s_waitcnt vmcnt(2)
    v_mfma_f32_32x32x16_bf16 v[64:79], v[104:107], v[204:207], v[64:79]
    v_mfma_f32_32x32x16_bf16 v[128:143], v[108:111], v[204:207], v[128:143]
    s_waitcnt vmcnt(1)
    v_mfma_f32_32x32x16_bf16 v[64:79], v[112:115], v[208:211], v[64:79]
    v_mfma_f32_32x32x16_bf16 v[128:143], v[116:119], v[208:211], v[128:143]
    s_waitcnt vmcnt(0)
    v_mfma_f32_32x32x16_bf16 v[64:79], v[120:123], v[212:215], v[64:79]
    v_mfma_f32_32x32x16_bf16 v[128:143], v[124:127], v[212:215], v[128:143]
    s_nop 10
    v_mul_f32 v64, v64, v253
    v_mul_f32 v65, v65, v253
    v_mul_f32 v66, v66, v253
    v_mul_f32 v67, v67, v253
    v_mul_f32 v68, v68, v253
    v_mul_f32 v69, v69, v253
    v_mul_f32 v70, v70, v253
    v_mul_f32 v71, v71, v253
    v_mul_f32 v72, v72, v253
    v_mul_f32 v73, v73, v253
    v_mul_f32 v74, v74, v253
    v_mul_f32 v75, v75, v253
    v_mul_f32 v76, v76, v253
    v_mul_f32 v77, v77, v253
    v_mul_f32 v78, v78, v253
    v_mul_f32 v79, v79, v253
    v_mul_f32 v128, v128, v253
    v_mul_f32 v129, v129, v253
    v_mul_f32 v130, v130, v253
    v_mul_f32 v131, v131, v253
    v_mul_f32 v132, v132, v253
    v_mul_f32 v133, v133, v253
    v_mul_f32 v134, v134, v253
    v_mul_f32 v135, v135, v253
    v_mul_f32 v136, v136, v253
    v_mul_f32 v137, v137, v253
    v_mul_f32 v138, v138, v253
    v_mul_f32 v139, v139, v253
    v_mul_f32 v140, v140, v253
    v_mul_f32 v141, v141, v253
    v_mul_f32 v142, v142, v253
    v_mul_f32 v143, v143, v253
    v_cmp_eq_u32 vcc, 0, v16
    s_nop 1
    s_and_b32 s74, vcc_lo, 3
    s_cbranch_scc0 L_ok13
    s_mov_b32 s75, 40000
L_sp13:
    s_sleep 2
    buffer_load_dword v16, v14, s[40:43], s13 offen sc1
    s_waitcnt vmcnt(0)
    v_cmp_eq_u32 vcc, 0, v16
    s_sub_u32 s75, s75, 1
    s_cmp_eq_u32 s75, 0
    s_cbranch_scc1 L_ok13
    s_and_b32 s74, vcc_lo, 3
    s_cbranch_scc1 L_sp13
L_ok13:
    buffer_load_dwordx4 v[216:219], v1, s[40:43], s85 offen offset:0 sc1
    v_mov_b32 v223, 0
    buffer_load_dwordx3 v[220:222], v5, s[40:43], s85 offen offset:1024 sc1
    buffer_load_dwordx4 v[224:227], v1, s[40:43], s85 offen offset:2048 sc1
    v_mov_b32 v231, 0
    buffer_load_dwordx3 v[228:230], v5, s[40:43], s85 offen offset:3072 sc1
    buffer_load_dwordx4 v[232:235], v1, s[40:43], s86 offen offset:0 sc1
    v_mov_b32 v239, 0
    buffer_load_dwordx3 v[236:238], v5, s[40:43], s86 offen offset:1024 sc1
    buffer_load_dwordx4 v[240:243], v1, s[40:43], s86 offen offset:2048 sc1
    v_mov_b32 v247, 0
    buffer_load_dwordx3 v[244:246], v5, s[40:43], s86 offen offset:3072 sc1
    s_waitcnt vmcnt(7) lgkmcnt(6)
    v_mfma_f32_32x32x16_bf16 v[32:47], v[80:83], v[216:219], v[32:47]
    s_waitcnt lgkmcnt(4)
    v_mfma_f32_32x32x16_bf16 v[48:63], v[84:87], v[216:219], v[48:63]
    s_waitcnt vmcnt(6) lgkmcnt(2)
    v_mfma_f32_32x32x16_bf16 v[32:47], v[88:91], v[220:223], v[32:47]
    s_waitcnt lgkmcnt(0)
    v_mfma_f32_32x32x16_bf16 v[48:63], v[92:95], v[220:223], v[48:63]
    s_waitcnt vmcnt(5)
    v_mfma_f32_32x32x16_bf16 v[32:47], v[144:147], v[224:227], v[32:47]
    v_mfma_f32_32x32x16_bf16 v[48:63], v[148:151], v[224:227], v[48:63]
    s_waitcnt vmcnt(4)
    v_mfma_f32_32x32x16_bf16 v[32:47], v[152:155], v[228:231], v[32:47]
    v_mfma_f32_32x32x16_bf16 v[48:63], v[156:159], v[228:231], v[48:63]
L_o_join:
    s_waitcnt vmcnt(3)
    v_mfma_f32_32x32x16_bf16 v[64:79], v[80:83], v[232:235], v[64:79]
    v_mfma_f32_32x32x16_bf16 v[128:143], v[84:87], v[232:235], v[128:143]
    s_waitcnt vmcnt(2)
    v_mfma_f32_32x32x16_bf16 v[64:79], v[88:91], v[236:239], v[64:79]
    s_nop 6
    v_mfma_f32_32x32x16_bf16 v[128:143], v[92:95], v[236:239], v[128:143]
    v_cvt_pk_bf16_f32 v32, v32, v33
    v_cvt_pk_bf16_f32 v33, v34, v35
    v_cvt_pk_bf16_f32 v34, v36, v37
    s_waitcnt vmcnt(1)
    v_mfma_f32_32x32x16_bf16 v[64:79], v[144:147], v[240:243], v[64:79]
    v_cvt_pk_bf16_f32 v35, v38, v39
    ds_write_b128 v3, v[32:35] offset:49152
    v_cvt_pk_bf16_f32 v36, v40, v41
    v_cvt_pk_bf16_f32 v37, v42, v43
    v_mfma_f32_32x32x16_bf16 v[128:143], v[148:151], v[240:243], v[128:143]
    v_cvt_pk_bf16_f32 v38, v44, v45
    v_cvt_pk_bf16_f32 v39, v46, v47
    ds_write_b128 v7, v[36:39] offset:50176
    v_cvt_pk_bf16_f32 v48, v48, v49
    v_cvt_pk_bf16_f32 v49, v50, v51
    s_waitcnt vmcnt(0)
    v_mfma_f32_32x32x16_bf16 v[64:79], v[152:155], v[244:247], v[64:79]
    v_cvt_pk_bf16_f32 v50, v52, v53
    v_cvt_pk_bf16_f32 v51, v54, v55
    ds_write_b128 v3, v[48:51] offset:51200
    v_cvt_pk_bf16_f32 v52, v56, v57
    v_mfma_f32_32x32x16_bf16 v[128:143], v[156:159], v[244:247], v[128:143]
    v_cvt_pk_bf16_f32 v53, v58, v59
    v_cvt_pk_bf16_f32 v54, v60, v61
    v_cvt_pk_bf16_f32 v55, v62, v63
    ds_write_b128 v7, v[52:55] offset:52224
    s_nop 2
    v_cvt_pk_bf16_f32 v64, v64, v65
    v_cvt_pk_bf16_f32 v65, v66, v67
    v_cvt_pk_bf16_f32 v66, v68, v69
    v_cvt_pk_bf16_f32 v67, v70, v71
    ds_write_b128 v3, v[64:67] offset:0
    v_cvt_pk_bf16_f32 v68, v72, v73
    v_cvt_pk_bf16_f32 v69, v74, v75
    v_cvt_pk_bf16_f32 v70, v76, v77
    v_cvt_pk_bf16_f32 v71, v78, v79
    ds_write_b128 v7, v[68:71] offset:1024
    v_cvt_pk_bf16_f32 v128, v128, v129
    v_cvt_pk_bf16_f32 v129, v130, v131
    v_cvt_pk_bf16_f32 v130, v132, v133
    v_cvt_pk_bf16_f32 v131, v134, v135
    ds_write_b128 v3, v[128:131] offset:2048
    v_cvt_pk_bf16_f32 v132, v136, v137
    v_cvt_pk_bf16_f32 v133, v138, v139
    v_cvt_pk_bf16_f32 v134, v140, v141
    v_cvt_pk_bf16_f32 v135, v142, v143
    ds_write_b128 v7, v[132:135] offset:3072
    s_waitcnt lgkmcnt(0)
    s_barrier
    ds_read_b128 v[200:203], v4 offset:0
    ds_read_b128 v[204:207], v255 offset:0
    ds_read_b128 v[208:211], v4 offset:12288
    ds_read_b128 v[212:215], v255 offset:12288
    ds_read_b128 v[216:219], v4 offset:24576
    ds_read_b128 v[220:223], v255 offset:24576
    ds_read_b128 v[224:227], v4 offset:36864
    ds_read_b128 v[228:231], v255 offset:36864
    s_waitcnt lgkmcnt(7)
    v_mfma_f32_16x16x32_bf16 v[164:167], v[248:251], v[200:203], 0
    s_waitcnt lgkmcnt(6)
    v_mfma_f32_16x16x32_bf16 v[168:171], v[248:251], v[204:207], 0
    s_waitcnt lgkmcnt(5)
    v_mfma_f32_16x16x32_bf16 v[164:167], v[248:251], v[208:211], v[164:167]
    s_waitcnt lgkmcnt(4)
    v_mfma_f32_16x16x32_bf16 v[168:171], v[248:251], v[212:215], v[168:171]
    s_waitcnt lgkmcnt(3)
    v_mfma_f32_16x16x32_bf16 v[164:167], v[248:251], v[216:219], v[164:167]
    s_waitcnt lgkmcnt(2)
    v_mfma_f32_16x16x32_bf16 v[168:171], v[248:251], v[220:223], v[168:171]
    s_waitcnt lgkmcnt(1)
    v_mfma_f32_16x16x32_bf16 v[164:167], v[248:251], v[224:227], v[164:167]
    s_waitcnt lgkmcnt(0)
    v_mfma_f32_16x16x32_bf16 v[168:171], v[248:251], v[228:231], v[168:171]
    s_nop 5
    v_cvt_pk_bf16_f32 v160, v164, v165
    v_cvt_pk_bf16_f32 v161, v166, v167
    v_cvt_pk_bf16_f32 v162, v168, v169
    v_cvt_pk_bf16_f32 v163, v170, v171
    s_nop 0
    v_permlane16_swap_b32 v160, v162
    v_permlane16_swap_b32 v161, v163
    buffer_store_dwordx4 v[160:163], v6, s[52:55], s23 offen nt
L_fin:

L_end:
    s_endpgm
L_code_end:
.section .rodata,"a"
.p2align 6
.amdhsa_kernel gated_mix__linear_kernel_hedgehog__glu_gated_swiglu__prompt_kernel
  .amdhsa_next_free_vgpr 256
  .amdhsa_next_free_sgpr 102
  .amdhsa_accum_offset 256
  .amdhsa_group_segment_fixed_size 0
  .amdhsa_kernarg_size 96
  .amdhsa_user_sgpr_count 2
  .amdhsa_user_sgpr_kernarg_segment_ptr 1
  .amdhsa_system_sgpr_workgroup_id_x 1
.end_amdhsa_kernel
.text
```
